```python
import torch

def _softmax(x, axis=-1):
    return torch.softmax(x, dim=axis)
def _gelu(x):
    return torch.nn.functional.gelu(x, approximate="tanh")
def _silu(x):
    return torch.nn.functional.silu(x)
def _sigmoid(x):
    return torch.sigmoid(x)
def _layernorm(x, axis=-1, eps=1e-5):
    m = x.mean(dim=axis, keepdim=True)
    v = x.var(dim=axis, keepdim=True, unbiased=False)
    return (x - m) / torch.sqrt(v + eps)
def _scatter_add(tgt, idx, src, axis=0):
    return tgt.clone().index_add_(axis, idx, src)
def _segment_sum(src, seg, n):
    out = torch.zeros((n,) + src.shape[1:], dtype=src.dtype)
    return out.index_add_(0, seg, src)
def _pad(x, pw):
    flat = tuple(v for pair in reversed(pw) for v in pair)
    return torch.nn.functional.pad(x, flat)

kernel_name = 'gated_mix__linear_attn_block__linear_kernel_hedgehog__prompt'

def setup_inputs():

    _w = (lambda a: (lambda t: t.to(torch.bfloat16) if t.is_floating_point() else t)(torch.as_tensor(a)))
    def _A_setup():
        B, S, D = 1, 2048, 576
        return {
            "x": _w((lambda *s: torch.randn(*s, dtype=torch.bfloat16) * 0.05)(B, S, D)),
            "wqkv": _w((lambda *s: torch.randn(*s, dtype=torch.bfloat16) * 1.6)(D, 3 * D)),
            "wo": _w((lambda *s: torch.randn(*s, dtype=torch.bfloat16) * 0.1)(D, D)),
        }
    _A_in = _A_setup()

    def _B_setup():
        B, S, D, H = 1, 2048, 576, 32
        Dh = D // H
        return {
            "x": _w((lambda *s: torch.randn(*s, dtype=torch.bfloat16) * 0.05)(B, S, D)),
            "wqkv": _w((lambda *s: torch.randn(*s, dtype=torch.bfloat16) * 1.6)(D, 3 * D)),
            "w_phi": _w((lambda *s: torch.randn(*s, dtype=torch.bfloat16) * 1.6)(H, Dh, Dh) * (Dh ** -0.5)),
            "wo": _w((lambda *s: torch.randn(*s, dtype=torch.bfloat16) * 0.05)(D, D)),
        }
    _B_in = _B_setup()

    return {
        "A_x": _A_in["x"],
        "A_wqkv": _A_in["wqkv"],
        "A_wo": _A_in["wo"],
        "B_x": _B_in["x"],
        "B_wqkv": _B_in["wqkv"],
        "B_w_phi": _B_in["w_phi"],
        "B_wo": _B_in["wo"],
        "gate_w": _w((lambda *s: torch.randn(*s, dtype=torch.bfloat16) * 0.05)(576) * 16.0),
    }

def reference(A_x, A_wqkv, A_wo, B_x, B_wqkv, B_w_phi, B_wo, gate_w):
    def _A_ref(x, wqkv, wo):
        B, S, D = x.shape
        H = 32; Dh = D // H
        qkv = (lambda x, *d: x.permute(*d))((x @ wqkv).reshape(B, S, 3, H, Dh), 2, 0, 3, 1, 4)
        q, k, v = qkv[0], qkv[1], qkv[2]
        phi = lambda t: torch.where(t > 0, t + 1, torch.exp(t)) + 1e-6
        pq, pk = phi(q), phi(k)
        kv = torch.einsum("bhsd,bhse->bhde", pk, v)
        z = torch.einsum("bhsd->bhd", pk)
        num = torch.einsum("bhqd,bhde->bhqe", pq, kv)
        den = torch.einsum("bhqd,bhd->bhq", pq, z)[..., None] + 1e-6
        o = num / den
        return (lambda x, *d: x.permute(*d))(o, 0, 2, 1, 3).reshape(B, S, D) @ wo

    def _B_ref(x, wqkv, w_phi, wo):
        B, S, D = x.shape
        H = 32; Dh = D // H
        qkv = (lambda x, *d: x.permute(*d))((x @ wqkv).reshape(B, S, 3, H, Dh), 2, 0, 3, 1, 4)
        q, k, v = qkv[0], qkv[1], qkv[2]
        pq = torch.einsum("bhsd,hdf->bhsf", q, w_phi)
        pk = torch.einsum("bhsd,hdf->bhsf", k, w_phi)
        phi_q = torch.concatenate([_softmax(pq, axis=-1), _softmax(-pq, axis=-1)], axis=-1)
        phi_k = torch.concatenate([_softmax(pk, axis=-1), _softmax(-pk, axis=-1)], axis=-1)
        kv = torch.einsum("bhsf,bhsd->bhfd", phi_k, v)
        z  = torch.einsum("bhsf->bhf", phi_k)
        num = torch.einsum("bhqf,bhfd->bhqd", phi_q, kv)
        den = torch.einsum("bhqf,bhf->bhq", phi_q, z)[..., None] + 1e-6
        o = num / den
        return (lambda x, *d: x.permute(*d))(o, 0, 2, 1, 3).reshape(B, S, D) @ wo

    x = A_x
    g = _sigmoid((x * gate_w).sum(-1, keepdims=True))
    a = _A_ref(x, A_wqkv, A_wo)
    b = _B_ref(x, B_wqkv, B_w_phi, B_wo)
    return g * a + (1 - g) * b
```

```asm
; @launch kernel=k1_kernel grid=(256,1,1) block=(512,1,1) lds=135168
; @launch kernel=k2a_kernel grid=(256,1,1) block=(256,1,1) lds=24576
; @launch kernel=k2b_kernel grid=(256,1,1) block=(256,1,1) lds=81920
.amdgcn_target "amdgcn-amd-amdhsa--gfx950"
.text
.globl k1_kernel
.p2align 8
.type k1_kernel,@function
k1_kernel:
  s_cmp_ge_u32 s2, 256
  s_cbranch_scc1 k1_end
  s_load_dwordx2 s[6:7], s[0:1], 0
  s_load_dwordx2 s[32:33], s[0:1], 8
  s_load_dwordx2 s[34:35], s[0:1], 32
  s_load_dwordx2 s[36:37], s[0:1], 80
  v_lshrrev_b32 v193, 6, v0
  v_and_b32 v192, 63, v0
  v_readfirstlane_b32 s24, v193
  s_lshr_b32 s27, s2, 4
  s_and_b32 s28, s2, 15
  s_lshr_b32 s29, s28, 3
  s_and_b32 s30, s28, 7
  s_and_b32 s25, s24, 3
  s_lshr_b32 s26, s24, 2
  s_waitcnt lgkmcnt(0)
  s_cmp_eq_u32 s29, 0
  s_cselect_b32 s4, s32, s34
  s_cselect_b32 s5, s33, s35
  s_mov_b32 s8, s4
  s_and_b32 s9, s5, 0xffff
  s_mov_b32 s10, 0x1e6000
  s_mov_b32 s11, 0x20000
  s_mov_b32 s12, s6
  s_and_b32 s13, s7, 0xffff
  s_mov_b32 s14, 0x240000
  s_mov_b32 s15, 0x20000
  s_mov_b32 s16, s36
  s_and_b32 s17, s37, 0xffff
  s_mov_b32 s18, 0x10000000
  s_mov_b32 s19, 0x20000
  v_lshrrev_b32 v193, 5, v192
  v_lshrrev_b32 v194, 4, v192
  v_and_b32 v194, 1, v194
  v_and_b32 v195, 15, v192
  v_lshrrev_b32 v196, 2, v195
  v_and_b32 v197, 3, v195
  v_lshl_add_u32 v198, v193, 3, v196
  v_mul_u32_u24 v198, 448, v198
  v_lshlrev_b32 v199, 5, v194
  v_lshl_add_u32 v199, v197, 3, v199
  v_add_u32 v176, v198, v199
  v_add_u32 v177, 45056, v176
  v_add_u32 v178, 90112, v176
  s_cmp_eq_u32 s26, 0
  s_cbranch_scc0 k1_role1
  v_and_b32 v193, 31, v192
  v_lshrrev_b32 v194, 5, v192
  v_bfe_u32 v195, v192, 1, 3
  s_lshl_b32 s31, s25, 12
  s_add_u32 s31, s31, 28672
  v_lshlrev_b32 v196, 7, v193
  v_add_u32 v196, s31, v196
  v_add_u32 v197, 0, v194
  v_xor_b32 v197, v197, v195
  v_lshl_add_u32 v179, v197, 4, v196
  v_add_u32 v180, 45056, v179
  v_add_u32 v181, 90112, v179
  v_add_u32 v197, 2, v194
  v_xor_b32 v197, v197, v195
  v_lshl_add_u32 v182, v197, 4, v196
  v_add_u32 v183, 45056, v182
  v_add_u32 v184, 90112, v182
  s_mul_i32 s38, s30, 144
  v_add_u32 v193, 0, v192
  v_mul_u32_u24 v194, 2341, v193
  v_lshrrev_b32 v194, 16, v194
  v_mul_u32_u24 v195, 28, v194
  v_sub_u32 v195, v193, v195
  v_min_u32 v195, 26, v195
  v_mul_u32_u24 v196, 29, v195
  v_lshrrev_b32 v196, 8, v196
  v_mul_u32_u24 v197, 9, v196
  v_sub_u32 v197, v195, v197
  v_mul_u32_u24 v198, 3456, v194
  v_mul_u32_u24 v199, 1152, v196
  v_add3_u32 v198, v198, v199, s38
  v_lshl_add_u32 v185, v197, 4, v198
  v_add_u32 v193, 64, v192
  v_mul_u32_u24 v194, 2341, v193
  v_lshrrev_b32 v194, 16, v194
  v_mul_u32_u24 v195, 28, v194
  v_sub_u32 v195, v193, v195
  v_min_u32 v195, 26, v195
  v_mul_u32_u24 v196, 29, v195
  v_lshrrev_b32 v196, 8, v196
  v_mul_u32_u24 v197, 9, v196
  v_sub_u32 v197, v195, v197
  v_mul_u32_u24 v198, 3456, v194
  v_mul_u32_u24 v199, 1152, v196
  v_add3_u32 v198, v198, v199, s38
  v_lshl_add_u32 v186, v197, 4, v198
  v_add_u32 v193, 128, v192
  v_mul_u32_u24 v194, 2341, v193
  v_lshrrev_b32 v194, 16, v194
  v_mul_u32_u24 v195, 28, v194
  v_sub_u32 v195, v193, v195
  v_min_u32 v195, 26, v195
  v_mul_u32_u24 v196, 29, v195
  v_lshrrev_b32 v196, 8, v196
  v_mul_u32_u24 v197, 9, v196
  v_sub_u32 v197, v195, v197
  v_mul_u32_u24 v198, 3456, v194
  v_mul_u32_u24 v199, 1152, v196
  v_add3_u32 v198, v198, v199, s38
  v_lshl_add_u32 v187, v197, 4, v198
  v_add_u32 v193, 192, v192
  v_mul_u32_u24 v194, 2341, v193
  v_lshrrev_b32 v194, 16, v194
  v_mul_u32_u24 v195, 28, v194
  v_sub_u32 v195, v193, v195
  v_min_u32 v195, 26, v195
  v_mul_u32_u24 v196, 29, v195
  v_lshrrev_b32 v196, 8, v196
  v_mul_u32_u24 v197, 9, v196
  v_sub_u32 v197, v195, v197
  v_mul_u32_u24 v198, 3456, v194
  v_mul_u32_u24 v199, 1152, v196
  v_add3_u32 v198, v198, v199, s38
  v_lshl_add_u32 v188, v197, 4, v198
  v_add_u32 v193, 256, v192
  v_mul_u32_u24 v194, 2341, v193
  v_lshrrev_b32 v194, 16, v194
  v_mul_u32_u24 v195, 28, v194
  v_sub_u32 v195, v193, v195
  v_min_u32 v195, 26, v195
  v_mul_u32_u24 v196, 29, v195
  v_lshrrev_b32 v196, 8, v196
  v_mul_u32_u24 v197, 9, v196
  v_sub_u32 v197, v195, v197
  v_mul_u32_u24 v198, 3456, v194
  v_mul_u32_u24 v199, 1152, v196
  v_add3_u32 v198, v198, v199, s38
  v_lshl_add_u32 v189, v197, 4, v198
  v_add_u32 v193, 320, v192
  v_mul_u32_u24 v194, 2341, v193
  v_lshrrev_b32 v194, 16, v194
  v_mul_u32_u24 v195, 28, v194
  v_sub_u32 v195, v193, v195
  v_min_u32 v195, 26, v195
  v_mul_u32_u24 v196, 29, v195
  v_lshrrev_b32 v196, 8, v196
  v_mul_u32_u24 v197, 9, v196
  v_sub_u32 v197, v195, v197
  v_mul_u32_u24 v198, 3456, v194
  v_mul_u32_u24 v199, 1152, v196
  v_add3_u32 v198, v198, v199, s38
  v_lshl_add_u32 v190, v197, 4, v198
  v_add_u32 v193, 384, v192
  v_mul_u32_u24 v194, 2341, v193
  v_lshrrev_b32 v194, 16, v194
  v_mul_u32_u24 v195, 28, v194
  v_sub_u32 v195, v193, v195
  v_min_u32 v195, 26, v195
  v_mul_u32_u24 v196, 29, v195
  v_lshrrev_b32 v196, 8, v196
  v_mul_u32_u24 v197, 9, v196
  v_sub_u32 v197, v195, v197
  v_mul_u32_u24 v198, 3456, v194
  v_mul_u32_u24 v199, 1152, v196
  v_add3_u32 v198, v198, v199, s38
  v_lshl_add_u32 v191, v197, 4, v198
  s_mul_i32 s39, s25, 55296
  s_add_u32 s40, s39, 0
  s_mul_i32 s41, s25, 7168
  s_add_u32 m0, s41, 0
  s_nop 0
  buffer_load_dwordx4 v185, s[8:11], s40 offen lds
  s_mul_i32 s41, s25, 7168
  s_add_u32 m0, s41, 1024
  s_nop 0
  buffer_load_dwordx4 v186, s[8:11], s40 offen lds
  s_mul_i32 s41, s25, 7168
  s_add_u32 m0, s41, 2048
  s_nop 0
  buffer_load_dwordx4 v187, s[8:11], s40 offen lds
  s_mul_i32 s41, s25, 7168
  s_add_u32 m0, s41, 3072
  s_nop 0
  buffer_load_dwordx4 v188, s[8:11], s40 offen lds
  s_mul_i32 s41, s25, 7168
  s_add_u32 m0, s41, 4096
  s_nop 0
  buffer_load_dwordx4 v189, s[8:11], s40 offen lds
  s_mul_i32 s41, s25, 7168
  s_add_u32 m0, s41, 5120
  s_nop 0
  buffer_load_dwordx4 v190, s[8:11], s40 offen lds
  s_mul_i32 s41, s25, 7168
  s_add_u32 m0, s41, 6144
  s_nop 0
  buffer_load_dwordx4 v191, s[8:11], s40 offen lds
  s_add_u32 s40, s39, 221184
  s_mul_i32 s41, s25, 7168
  s_add_u32 m0, s41, 45056
  s_nop 0
  buffer_load_dwordx4 v185, s[8:11], s40 offen lds
  s_mul_i32 s41, s25, 7168
  s_add_u32 m0, s41, 46080
  s_nop 0
  buffer_load_dwordx4 v186, s[8:11], s40 offen lds
  s_mul_i32 s41, s25, 7168
  s_add_u32 m0, s41, 47104
  s_nop 0
  buffer_load_dwordx4 v187, s[8:11], s40 offen lds
  s_mul_i32 s41, s25, 7168
  s_add_u32 m0, s41, 48128
  s_nop 0
  buffer_load_dwordx4 v188, s[8:11], s40 offen lds
  s_mul_i32 s41, s25, 7168
  s_add_u32 m0, s41, 49152
  s_nop 0
  buffer_load_dwordx4 v189, s[8:11], s40 offen lds
  s_mul_i32 s41, s25, 7168
  s_add_u32 m0, s41, 50176
  s_nop 0
  buffer_load_dwordx4 v190, s[8:11], s40 offen lds
  s_mul_i32 s41, s25, 7168
  s_add_u32 m0, s41, 51200
  s_nop 0
  buffer_load_dwordx4 v191, s[8:11], s40 offen lds
  s_add_u32 s40, s39, 442368
  s_mul_i32 s41, s25, 7168
  s_add_u32 m0, s41, 90112
  s_nop 0
  buffer_load_dwordx4 v185, s[8:11], s40 offen lds
  s_mul_i32 s41, s25, 7168
  s_add_u32 m0, s41, 91136
  s_nop 0
  buffer_load_dwordx4 v186, s[8:11], s40 offen lds
  s_mul_i32 s41, s25, 7168
  s_add_u32 m0, s41, 92160
  s_nop 0
  buffer_load_dwordx4 v187, s[8:11], s40 offen lds
  s_mul_i32 s41, s25, 7168
  s_add_u32 m0, s41, 93184
  s_nop 0
  buffer_load_dwordx4 v188, s[8:11], s40 offen lds
  s_mul_i32 s41, s25, 7168
  s_add_u32 m0, s41, 94208
  s_nop 0
  buffer_load_dwordx4 v189, s[8:11], s40 offen lds
  s_mul_i32 s41, s25, 7168
  s_add_u32 m0, s41, 95232
  s_nop 0
  buffer_load_dwordx4 v190, s[8:11], s40 offen lds
  s_mul_i32 s41, s25, 7168
  s_add_u32 m0, s41, 96256
  s_nop 0
  buffer_load_dwordx4 v191, s[8:11], s40 offen lds
  s_load_dwordx2 s[48:49], s[0:1], 40
  v_and_b32 v193, 31, v192
  v_lshrrev_b32 v194, 5, v192
  v_mov_b32 v195, 0x7fff0000
  v_cmp_eq_u32 vcc, 20, v193
  s_nop 1
  v_cndmask_b32 v196, v195, 17, vcc
  v_cmp_ge_u32 vcc, 16, v193
  s_nop 1
  v_cndmask_b32 v196, v196, v193, vcc
  v_cmp_ge_u32 vcc, 17, v196
  v_lshlrev_b32 v197, 1, v196
  s_nop 0
  v_cndmask_b32 v196, v196, v197, vcc
  v_mul_u32_u24 v197, 144, v194
  v_add_u32 v197, v197, v196
  v_cmp_eq_u32 vcc, 1, v194
  s_nop 1
  v_cndmask_b32 v198, v195, v196, vcc
  v_cndmask_b32 v199, v196, v195, vcc
  s_waitcnt lgkmcnt(0)
  s_mov_b32 s20, s48
  s_and_b32 s21, s49, 0xffff
  s_mov_b32 s22, 0x5100
  s_mov_b32 s23, 0x20000
  s_lshl_b32 s47, s30, 2
  s_add_u32 s48, s47, 0
  s_mul_i32 s48, s48, 648
  buffer_load_ushort v208, v197, s[20:23], s48 offen offset:0
  buffer_load_ushort v209, v197, s[20:23], s48 offen offset:36
  buffer_load_ushort v210, v197, s[20:23], s48 offen offset:72
  buffer_load_ushort v211, v197, s[20:23], s48 offen offset:108
  buffer_load_ushort v212, v197, s[20:23], s48 offen offset:288
  buffer_load_ushort v213, v197, s[20:23], s48 offen offset:324
  buffer_load_ushort v214, v197, s[20:23], s48 offen offset:360
  buffer_load_ushort v215, v197, s[20:23], s48 offen offset:396
  buffer_load_ushort v216, v199, s[20:23], s48 offen offset:576
  buffer_load_ushort v217, v199, s[20:23], s48 offen offset:612
  v_mov_b32 v218, 0
  v_mov_b32 v219, 0
  v_mov_b32 v220, 0
  v_mov_b32 v221, 0
  v_mov_b32 v222, 0
  v_mov_b32 v223, 0
  s_add_u32 s48, s47, 1
  s_mul_i32 s48, s48, 648
  buffer_load_ushort v224, v198, s[20:23], s48 offen offset:72
  buffer_load_ushort v225, v198, s[20:23], s48 offen offset:108
  buffer_load_ushort v226, v197, s[20:23], s48 offen offset:0
  buffer_load_ushort v227, v197, s[20:23], s48 offen offset:36
  buffer_load_ushort v228, v197, s[20:23], s48 offen offset:216
  buffer_load_ushort v229, v197, s[20:23], s48 offen offset:252
  buffer_load_ushort v230, v197, s[20:23], s48 offen offset:288
  buffer_load_ushort v231, v197, s[20:23], s48 offen offset:324
  buffer_load_ushort v232, v199, s[20:23], s48 offen offset:504
  buffer_load_ushort v233, v199, s[20:23], s48 offen offset:540
  buffer_load_ushort v234, v199, s[20:23], s48 offen offset:576
  buffer_load_ushort v235, v199, s[20:23], s48 offen offset:612
  v_mov_b32 v236, 0
  v_mov_b32 v237, 0
  v_mov_b32 v238, 0
  v_mov_b32 v239, 0
  s_waitcnt vmcnt(36)
  s_barrier
  ds_read_b128 v[168:171], v179
  ds_read_b64_tr_b16 v[112:113], v176 offset:0
  ds_read_b64_tr_b16 v[114:115], v176 offset:1792
  ds_read_b64_tr_b16 v[116:117], v176 offset:64
  ds_read_b64_tr_b16 v[118:119], v176 offset:1856
  ds_read_b64_tr_b16 v[120:121], v176 offset:128
  ds_read_b64_tr_b16 v[122:123], v176 offset:1920
  ds_read_b64_tr_b16 v[124:125], v176 offset:192
  ds_read_b64_tr_b16 v[126:127], v176 offset:1984
  ds_read_b64_tr_b16 v[128:129], v176 offset:256
  ds_read_b64_tr_b16 v[130:131], v176 offset:2048
  ds_read_b64_tr_b16 v[132:133], v176 offset:320
  ds_read_b64_tr_b16 v[134:135], v176 offset:2112
  ds_read_b64_tr_b16 v[136:137], v176 offset:384
  ds_read_b64_tr_b16 v[138:139], v176 offset:2176
  s_waitcnt lgkmcnt(12)
  v_mfma_f32_32x32x16_bf16 v[0:15], v[112:115], v[168:171], 0
  ds_read_b128 v[172:175], v182
  ds_read_b64_tr_b16 v[140:141], v176 offset:7168
  ds_read_b64_tr_b16 v[142:143], v176 offset:8960
  s_waitcnt lgkmcnt(13)
  ds_read_b64_tr_b16 v[144:145], v176 offset:7232
  ds_read_b64_tr_b16 v[146:147], v176 offset:9024
  v_mfma_f32_32x32x16_bf16 v[16:31], v[116:119], v[168:171], 0
  s_waitcnt lgkmcnt(13)
  ds_read_b64_tr_b16 v[148:149], v176 offset:7296
  ds_read_b64_tr_b16 v[150:151], v176 offset:9088
  s_waitcnt lgkmcnt(13)
  ds_read_b64_tr_b16 v[152:153], v176 offset:7360
  ds_read_b64_tr_b16 v[154:155], v176 offset:9152
  v_mfma_f32_32x32x16_bf16 v[32:47], v[120:123], v[168:171], 0
  s_waitcnt lgkmcnt(13)
  ds_read_b64_tr_b16 v[156:157], v176 offset:7424
  ds_read_b64_tr_b16 v[158:159], v176 offset:9216
  s_waitcnt lgkmcnt(13)
  ds_read_b64_tr_b16 v[160:161], v176 offset:7488
  ds_read_b64_tr_b16 v[162:163], v176 offset:9280
  v_mfma_f32_32x32x16_bf16 v[48:63], v[124:127], v[168:171], 0
  s_waitcnt lgkmcnt(13)
  ds_read_b64_tr_b16 v[164:165], v176 offset:7552
  ds_read_b64_tr_b16 v[166:167], v176 offset:9344
  v_mfma_f32_32x32x16_bf16 v[64:79], v[128:131], v[168:171], 0
  v_mfma_f32_32x32x16_bf16 v[80:95], v[132:135], v[168:171], 0
  v_mfma_f32_32x32x16_bf16 v[96:111], v[136:139], v[168:171], 0
  s_waitcnt lgkmcnt(0)
  s_waitcnt vmcnt(29)
  s_barrier
  s_add_u32 s40, s39, 663552
  s_mul_i32 s41, s25, 7168
  s_add_u32 m0, s41, 0
  s_nop 0
  buffer_load_dwordx4 v185, s[8:11], s40 offen lds
  s_mul_i32 s41, s25, 7168
  s_add_u32 m0, s41, 1024
  s_nop 0
  buffer_load_dwordx4 v186, s[8:11], s40 offen lds
  s_mul_i32 s41, s25, 7168
  s_add_u32 m0, s41, 2048
  s_nop 0
  buffer_load_dwordx4 v187, s[8:11], s40 offen lds
  s_mul_i32 s41, s25, 7168
  s_add_u32 m0, s41, 3072
  s_nop 0
  buffer_load_dwordx4 v188, s[8:11], s40 offen lds
  s_mul_i32 s41, s25, 7168
  s_add_u32 m0, s41, 4096
  s_nop 0
  buffer_load_dwordx4 v189, s[8:11], s40 offen lds
  s_mul_i32 s41, s25, 7168
  s_add_u32 m0, s41, 5120
  s_nop 0
  buffer_load_dwordx4 v190, s[8:11], s40 offen lds
  s_mul_i32 s41, s25, 7168
  s_add_u32 m0, s41, 6144
  s_nop 0
  buffer_load_dwordx4 v191, s[8:11], s40 offen lds
  v_mfma_f32_32x32x16_bf16 v[0:15], v[140:143], v[172:175], v[0:15]
  ds_read_b128 v[168:171], v180
  ds_read_b64_tr_b16 v[112:113], v177 offset:0
  ds_read_b64_tr_b16 v[114:115], v177 offset:1792
  ds_read_b64_tr_b16 v[116:117], v177 offset:64
  ds_read_b64_tr_b16 v[118:119], v177 offset:1856
  v_mfma_f32_32x32x16_bf16 v[16:31], v[144:147], v[172:175], v[16:31]
  ds_read_b64_tr_b16 v[120:121], v177 offset:128
  ds_read_b64_tr_b16 v[122:123], v177 offset:1920
  ds_read_b64_tr_b16 v[124:125], v177 offset:192
  ds_read_b64_tr_b16 v[126:127], v177 offset:1984
  v_mfma_f32_32x32x16_bf16 v[32:47], v[148:151], v[172:175], v[32:47]
  ds_read_b64_tr_b16 v[128:129], v177 offset:256
  ds_read_b64_tr_b16 v[130:131], v177 offset:2048
  ds_read_b64_tr_b16 v[132:133], v177 offset:320
  ds_read_b64_tr_b16 v[134:135], v177 offset:2112
  v_mfma_f32_32x32x16_bf16 v[48:63], v[152:155], v[172:175], v[48:63]
  ds_read_b64_tr_b16 v[136:137], v177 offset:384
  ds_read_b64_tr_b16 v[138:139], v177 offset:2176
  v_mfma_f32_32x32x16_bf16 v[64:79], v[156:159], v[172:175], v[64:79]
  v_mfma_f32_32x32x16_bf16 v[80:95], v[160:163], v[172:175], v[80:95]
  v_mfma_f32_32x32x16_bf16 v[96:111], v[164:167], v[172:175], v[96:111]
  s_waitcnt lgkmcnt(12)
  v_mfma_f32_32x32x16_bf16 v[0:15], v[112:115], v[168:171], v[0:15]
  ds_read_b128 v[172:175], v183
  ds_read_b64_tr_b16 v[140:141], v177 offset:7168
  ds_read_b64_tr_b16 v[142:143], v177 offset:8960
  s_waitcnt lgkmcnt(13)
  ds_read_b64_tr_b16 v[144:145], v177 offset:7232
  ds_read_b64_tr_b16 v[146:147], v177 offset:9024
  v_mfma_f32_32x32x16_bf16 v[16:31], v[116:119], v[168:171], v[16:31]
  s_waitcnt lgkmcnt(13)
  ds_read_b64_tr_b16 v[148:149], v177 offset:7296
  ds_read_b64_tr_b16 v[150:151], v177 offset:9088
  s_waitcnt lgkmcnt(13)
  ds_read_b64_tr_b16 v[152:153], v177 offset:7360
  ds_read_b64_tr_b16 v[154:155], v177 offset:9152
  v_mfma_f32_32x32x16_bf16 v[32:47], v[120:123], v[168:171], v[32:47]
  s_waitcnt lgkmcnt(13)
  ds_read_b64_tr_b16 v[156:157], v177 offset:7424
  ds_read_b64_tr_b16 v[158:159], v177 offset:9216
  s_waitcnt lgkmcnt(13)
  ds_read_b64_tr_b16 v[160:161], v177 offset:7488
  ds_read_b64_tr_b16 v[162:163], v177 offset:9280
  v_mfma_f32_32x32x16_bf16 v[48:63], v[124:127], v[168:171], v[48:63]
  s_waitcnt lgkmcnt(13)
  ds_read_b64_tr_b16 v[164:165], v177 offset:7552
  ds_read_b64_tr_b16 v[166:167], v177 offset:9344
  v_mfma_f32_32x32x16_bf16 v[64:79], v[128:131], v[168:171], v[64:79]
  v_mfma_f32_32x32x16_bf16 v[80:95], v[132:135], v[168:171], v[80:95]
  v_mfma_f32_32x32x16_bf16 v[96:111], v[136:139], v[168:171], v[96:111]
  s_waitcnt lgkmcnt(0)
  s_waitcnt vmcnt(29)
  s_barrier
  s_add_u32 s40, s39, 884736
  s_mul_i32 s41, s25, 7168
  s_add_u32 m0, s41, 45056
  s_nop 0
  buffer_load_dwordx4 v185, s[8:11], s40 offen lds
  s_mul_i32 s41, s25, 7168
  s_add_u32 m0, s41, 46080
  s_nop 0
  buffer_load_dwordx4 v186, s[8:11], s40 offen lds
  s_mul_i32 s41, s25, 7168
  s_add_u32 m0, s41, 47104
  s_nop 0
  buffer_load_dwordx4 v187, s[8:11], s40 offen lds
  s_mul_i32 s41, s25, 7168
  s_add_u32 m0, s41, 48128
  s_nop 0
  buffer_load_dwordx4 v188, s[8:11], s40 offen lds
  s_mul_i32 s41, s25, 7168
  s_add_u32 m0, s41, 49152
  s_nop 0
  buffer_load_dwordx4 v189, s[8:11], s40 offen lds
  s_mul_i32 s41, s25, 7168
  s_add_u32 m0, s41, 50176
  s_nop 0
  buffer_load_dwordx4 v190, s[8:11], s40 offen lds
  s_mul_i32 s41, s25, 7168
  s_add_u32 m0, s41, 51200
  s_nop 0
  buffer_load_dwordx4 v191, s[8:11], s40 offen lds
  v_mfma_f32_32x32x16_bf16 v[0:15], v[140:143], v[172:175], v[0:15]
  ds_read_b128 v[168:171], v181
  ds_read_b64_tr_b16 v[112:113], v178 offset:0
  ds_read_b64_tr_b16 v[114:115], v178 offset:1792
  ds_read_b64_tr_b16 v[116:117], v178 offset:64
  ds_read_b64_tr_b16 v[118:119], v178 offset:1856
  v_mfma_f32_32x32x16_bf16 v[16:31], v[144:147], v[172:175], v[16:31]
  ds_read_b64_tr_b16 v[120:121], v178 offset:128
  ds_read_b64_tr_b16 v[122:123], v178 offset:1920
  ds_read_b64_tr_b16 v[124:125], v178 offset:192
  ds_read_b64_tr_b16 v[126:127], v178 offset:1984
  v_mfma_f32_32x32x16_bf16 v[32:47], v[148:151], v[172:175], v[32:47]
  ds_read_b64_tr_b16 v[128:129], v178 offset:256
  ds_read_b64_tr_b16 v[130:131], v178 offset:2048
  ds_read_b64_tr_b16 v[132:133], v178 offset:320
  ds_read_b64_tr_b16 v[134:135], v178 offset:2112
  v_mfma_f32_32x32x16_bf16 v[48:63], v[152:155], v[172:175], v[48:63]
  ds_read_b64_tr_b16 v[136:137], v178 offset:384
  ds_read_b64_tr_b16 v[138:139], v178 offset:2176
  v_mfma_f32_32x32x16_bf16 v[64:79], v[156:159], v[172:175], v[64:79]
  v_mfma_f32_32x32x16_bf16 v[80:95], v[160:163], v[172:175], v[80:95]
  v_mfma_f32_32x32x16_bf16 v[96:111], v[164:167], v[172:175], v[96:111]
  s_waitcnt lgkmcnt(12)
  v_mfma_f32_32x32x16_bf16 v[0:15], v[112:115], v[168:171], v[0:15]
  ds_read_b128 v[172:175], v184
  ds_read_b64_tr_b16 v[140:141], v178 offset:7168
  ds_read_b64_tr_b16 v[142:143], v178 offset:8960
  s_waitcnt lgkmcnt(13)
  ds_read_b64_tr_b16 v[144:145], v178 offset:7232
  ds_read_b64_tr_b16 v[146:147], v178 offset:9024
  v_mfma_f32_32x32x16_bf16 v[16:31], v[116:119], v[168:171], v[16:31]
  s_waitcnt lgkmcnt(13)
  ds_read_b64_tr_b16 v[148:149], v178 offset:7296
  ds_read_b64_tr_b16 v[150:151], v178 offset:9088
  s_waitcnt lgkmcnt(13)
  ds_read_b64_tr_b16 v[152:153], v178 offset:7360
  ds_read_b64_tr_b16 v[154:155], v178 offset:9152
  v_mfma_f32_32x32x16_bf16 v[32:47], v[120:123], v[168:171], v[32:47]
  s_waitcnt lgkmcnt(13)
  ds_read_b64_tr_b16 v[156:157], v178 offset:7424
  ds_read_b64_tr_b16 v[158:159], v178 offset:9216
  s_waitcnt lgkmcnt(13)
  ds_read_b64_tr_b16 v[160:161], v178 offset:7488
  ds_read_b64_tr_b16 v[162:163], v178 offset:9280
  v_mfma_f32_32x32x16_bf16 v[48:63], v[124:127], v[168:171], v[48:63]
  s_waitcnt lgkmcnt(13)
  ds_read_b64_tr_b16 v[164:165], v178 offset:7552
  ds_read_b64_tr_b16 v[166:167], v178 offset:9344
  v_mfma_f32_32x32x16_bf16 v[64:79], v[128:131], v[168:171], v[64:79]
  v_mfma_f32_32x32x16_bf16 v[80:95], v[132:135], v[168:171], v[80:95]
  v_mfma_f32_32x32x16_bf16 v[96:111], v[136:139], v[168:171], v[96:111]
  s_waitcnt lgkmcnt(0)
  s_waitcnt vmcnt(7)
  s_barrier
  s_add_u32 s40, s39, 1105920
  s_mul_i32 s41, s25, 7168
  s_add_u32 m0, s41, 90112
  s_nop 0
  buffer_load_dwordx4 v185, s[8:11], s40 offen lds
  s_mul_i32 s41, s25, 7168
  s_add_u32 m0, s41, 91136
  s_nop 0
  buffer_load_dwordx4 v186, s[8:11], s40 offen lds
  s_mul_i32 s41, s25, 7168
  s_add_u32 m0, s41, 92160
  s_nop 0
  buffer_load_dwordx4 v187, s[8:11], s40 offen lds
  s_mul_i32 s41, s25, 7168
  s_add_u32 m0, s41, 93184
  s_nop 0
  buffer_load_dwordx4 v188, s[8:11], s40 offen lds
  s_mul_i32 s41, s25, 7168
  s_add_u32 m0, s41, 94208
  s_nop 0
  buffer_load_dwordx4 v189, s[8:11], s40 offen lds
  s_mul_i32 s41, s25, 7168
  s_add_u32 m0, s41, 95232
  s_nop 0
  buffer_load_dwordx4 v190, s[8:11], s40 offen lds
  s_mul_i32 s41, s25, 7168
  s_add_u32 m0, s41, 96256
  s_nop 0
  buffer_load_dwordx4 v191, s[8:11], s40 offen lds
  v_mfma_f32_32x32x16_bf16 v[0:15], v[140:143], v[172:175], v[0:15]
  ds_read_b128 v[168:171], v179
  ds_read_b64_tr_b16 v[112:113], v176 offset:0
  ds_read_b64_tr_b16 v[114:115], v176 offset:1792
  ds_read_b64_tr_b16 v[116:117], v176 offset:64
  ds_read_b64_tr_b16 v[118:119], v176 offset:1856
  v_mfma_f32_32x32x16_bf16 v[16:31], v[144:147], v[172:175], v[16:31]
  ds_read_b64_tr_b16 v[120:121], v176 offset:128
  ds_read_b64_tr_b16 v[122:123], v176 offset:1920
  ds_read_b64_tr_b16 v[124:125], v176 offset:192
  ds_read_b64_tr_b16 v[126:127], v176 offset:1984
  v_mfma_f32_32x32x16_bf16 v[32:47], v[148:151], v[172:175], v[32:47]
  ds_read_b64_tr_b16 v[128:129], v176 offset:256
  ds_read_b64_tr_b16 v[130:131], v176 offset:2048
  ds_read_b64_tr_b16 v[132:133], v176 offset:320
  ds_read_b64_tr_b16 v[134:135], v176 offset:2112
  v_mfma_f32_32x32x16_bf16 v[48:63], v[152:155], v[172:175], v[48:63]
  ds_read_b64_tr_b16 v[136:137], v176 offset:384
  ds_read_b64_tr_b16 v[138:139], v176 offset:2176
  v_mfma_f32_32x32x16_bf16 v[64:79], v[156:159], v[172:175], v[64:79]
  v_mfma_f32_32x32x16_bf16 v[80:95], v[160:163], v[172:175], v[80:95]
  v_mfma_f32_32x32x16_bf16 v[96:111], v[164:167], v[172:175], v[96:111]
  s_waitcnt lgkmcnt(12)
  v_mfma_f32_32x32x16_bf16 v[0:15], v[112:115], v[168:171], v[0:15]
  ds_read_b128 v[172:175], v182
  ds_read_b64_tr_b16 v[140:141], v176 offset:7168
  ds_read_b64_tr_b16 v[142:143], v176 offset:8960
  s_waitcnt lgkmcnt(13)
  ds_read_b64_tr_b16 v[144:145], v176 offset:7232
  ds_read_b64_tr_b16 v[146:147], v176 offset:9024
  v_mfma_f32_32x32x16_bf16 v[16:31], v[116:119], v[168:171], v[16:31]
  s_waitcnt lgkmcnt(13)
  ds_read_b64_tr_b16 v[148:149], v176 offset:7296
  ds_read_b64_tr_b16 v[150:151], v176 offset:9088
  s_waitcnt lgkmcnt(13)
  ds_read_b64_tr_b16 v[152:153], v176 offset:7360
  ds_read_b64_tr_b16 v[154:155], v176 offset:9152
  v_mfma_f32_32x32x16_bf16 v[32:47], v[120:123], v[168:171], v[32:47]
  s_waitcnt lgkmcnt(13)
  ds_read_b64_tr_b16 v[156:157], v176 offset:7424
  ds_read_b64_tr_b16 v[158:159], v176 offset:9216
  s_waitcnt lgkmcnt(13)
  ds_read_b64_tr_b16 v[160:161], v176 offset:7488
  ds_read_b64_tr_b16 v[162:163], v176 offset:9280
  v_mfma_f32_32x32x16_bf16 v[48:63], v[124:127], v[168:171], v[48:63]
  s_waitcnt lgkmcnt(13)
  ds_read_b64_tr_b16 v[164:165], v176 offset:7552
  ds_read_b64_tr_b16 v[166:167], v176 offset:9344
  v_mfma_f32_32x32x16_bf16 v[64:79], v[128:131], v[168:171], v[64:79]
  v_mfma_f32_32x32x16_bf16 v[80:95], v[132:135], v[168:171], v[80:95]
  v_mfma_f32_32x32x16_bf16 v[96:111], v[136:139], v[168:171], v[96:111]
  s_waitcnt lgkmcnt(0)
  s_waitcnt vmcnt(7)
  s_barrier
  s_add_u32 s40, s39, 1327104
  s_mul_i32 s41, s25, 7168
  s_add_u32 m0, s41, 0
  s_nop 0
  buffer_load_dwordx4 v185, s[8:11], s40 offen lds
  s_mul_i32 s41, s25, 7168
  s_add_u32 m0, s41, 1024
  s_nop 0
  buffer_load_dwordx4 v186, s[8:11], s40 offen lds
  s_mul_i32 s41, s25, 7168
  s_add_u32 m0, s41, 2048
  s_nop 0
  buffer_load_dwordx4 v187, s[8:11], s40 offen lds
  s_mul_i32 s41, s25, 7168
  s_add_u32 m0, s41, 3072
  s_nop 0
  buffer_load_dwordx4 v188, s[8:11], s40 offen lds
  s_mul_i32 s41, s25, 7168
  s_add_u32 m0, s41, 4096
  s_nop 0
  buffer_load_dwordx4 v189, s[8:11], s40 offen lds
  s_mul_i32 s41, s25, 7168
  s_add_u32 m0, s41, 5120
  s_nop 0
  buffer_load_dwordx4 v190, s[8:11], s40 offen lds
  s_mul_i32 s41, s25, 7168
  s_add_u32 m0, s41, 6144
  s_nop 0
  buffer_load_dwordx4 v191, s[8:11], s40 offen lds
  v_mfma_f32_32x32x16_bf16 v[0:15], v[140:143], v[172:175], v[0:15]
  ds_read_b128 v[168:171], v180
  ds_read_b64_tr_b16 v[112:113], v177 offset:0
  ds_read_b64_tr_b16 v[114:115], v177 offset:1792
  ds_read_b64_tr_b16 v[116:117], v177 offset:64
  ds_read_b64_tr_b16 v[118:119], v177 offset:1856
  v_mfma_f32_32x32x16_bf16 v[16:31], v[144:147], v[172:175], v[16:31]
  ds_read_b64_tr_b16 v[120:121], v177 offset:128
  ds_read_b64_tr_b16 v[122:123], v177 offset:1920
  ds_read_b64_tr_b16 v[124:125], v177 offset:192
  ds_read_b64_tr_b16 v[126:127], v177 offset:1984
  v_mfma_f32_32x32x16_bf16 v[32:47], v[148:151], v[172:175], v[32:47]
  ds_read_b64_tr_b16 v[128:129], v177 offset:256
  ds_read_b64_tr_b16 v[130:131], v177 offset:2048
  ds_read_b64_tr_b16 v[132:133], v177 offset:320
  ds_read_b64_tr_b16 v[134:135], v177 offset:2112
  v_mfma_f32_32x32x16_bf16 v[48:63], v[152:155], v[172:175], v[48:63]
  ds_read_b64_tr_b16 v[136:137], v177 offset:384
  ds_read_b64_tr_b16 v[138:139], v177 offset:2176
  v_mfma_f32_32x32x16_bf16 v[64:79], v[156:159], v[172:175], v[64:79]
  v_mfma_f32_32x32x16_bf16 v[80:95], v[160:163], v[172:175], v[80:95]
  v_mfma_f32_32x32x16_bf16 v[96:111], v[164:167], v[172:175], v[96:111]
  s_waitcnt lgkmcnt(12)
  v_mfma_f32_32x32x16_bf16 v[0:15], v[112:115], v[168:171], v[0:15]
  ds_read_b128 v[172:175], v183
  ds_read_b64_tr_b16 v[140:141], v177 offset:7168
  ds_read_b64_tr_b16 v[142:143], v177 offset:8960
  s_waitcnt lgkmcnt(13)
  ds_read_b64_tr_b16 v[144:145], v177 offset:7232
  ds_read_b64_tr_b16 v[146:147], v177 offset:9024
  v_mfma_f32_32x32x16_bf16 v[16:31], v[116:119], v[168:171], v[16:31]
  s_waitcnt lgkmcnt(13)
  ds_read_b64_tr_b16 v[148:149], v177 offset:7296
  ds_read_b64_tr_b16 v[150:151], v177 offset:9088
  s_waitcnt lgkmcnt(13)
  ds_read_b64_tr_b16 v[152:153], v177 offset:7360
  ds_read_b64_tr_b16 v[154:155], v177 offset:9152
  v_mfma_f32_32x32x16_bf16 v[32:47], v[120:123], v[168:171], v[32:47]
  s_waitcnt lgkmcnt(13)
  ds_read_b64_tr_b16 v[156:157], v177 offset:7424
  ds_read_b64_tr_b16 v[158:159], v177 offset:9216
  s_waitcnt lgkmcnt(13)
  ds_read_b64_tr_b16 v[160:161], v177 offset:7488
  ds_read_b64_tr_b16 v[162:163], v177 offset:9280
  v_mfma_f32_32x32x16_bf16 v[48:63], v[124:127], v[168:171], v[48:63]
  s_waitcnt lgkmcnt(13)
  ds_read_b64_tr_b16 v[164:165], v177 offset:7552
  ds_read_b64_tr_b16 v[166:167], v177 offset:9344
  v_mfma_f32_32x32x16_bf16 v[64:79], v[128:131], v[168:171], v[64:79]
  v_mfma_f32_32x32x16_bf16 v[80:95], v[132:135], v[168:171], v[80:95]
  v_mfma_f32_32x32x16_bf16 v[96:111], v[136:139], v[168:171], v[96:111]
  s_waitcnt lgkmcnt(0)
  s_waitcnt vmcnt(7)
  s_barrier
  s_add_u32 s40, s39, 1548288
  s_mul_i32 s41, s25, 7168
  s_add_u32 m0, s41, 45056
  s_nop 0
  buffer_load_dwordx4 v185, s[8:11], s40 offen lds
  s_mul_i32 s41, s25, 7168
  s_add_u32 m0, s41, 46080
  s_nop 0
  buffer_load_dwordx4 v186, s[8:11], s40 offen lds
  s_mul_i32 s41, s25, 7168
  s_add_u32 m0, s41, 47104
  s_nop 0
  buffer_load_dwordx4 v187, s[8:11], s40 offen lds
  s_mul_i32 s41, s25, 7168
  s_add_u32 m0, s41, 48128
  s_nop 0
  buffer_load_dwordx4 v188, s[8:11], s40 offen lds
  s_mul_i32 s41, s25, 7168
  s_add_u32 m0, s41, 49152
  s_nop 0
  buffer_load_dwordx4 v189, s[8:11], s40 offen lds
  s_mul_i32 s41, s25, 7168
  s_add_u32 m0, s41, 50176
  s_nop 0
  buffer_load_dwordx4 v190, s[8:11], s40 offen lds
  s_mul_i32 s41, s25, 7168
  s_add_u32 m0, s41, 51200
  s_nop 0
  buffer_load_dwordx4 v191, s[8:11], s40 offen lds
  v_mfma_f32_32x32x16_bf16 v[0:15], v[140:143], v[172:175], v[0:15]
  ds_read_b128 v[168:171], v181
  ds_read_b64_tr_b16 v[112:113], v178 offset:0
  ds_read_b64_tr_b16 v[114:115], v178 offset:1792
  ds_read_b64_tr_b16 v[116:117], v178 offset:64
  ds_read_b64_tr_b16 v[118:119], v178 offset:1856
  v_mfma_f32_32x32x16_bf16 v[16:31], v[144:147], v[172:175], v[16:31]
  ds_read_b64_tr_b16 v[120:121], v178 offset:128
  ds_read_b64_tr_b16 v[122:123], v178 offset:1920
  ds_read_b64_tr_b16 v[124:125], v178 offset:192
  ds_read_b64_tr_b16 v[126:127], v178 offset:1984
  v_mfma_f32_32x32x16_bf16 v[32:47], v[148:151], v[172:175], v[32:47]
  ds_read_b64_tr_b16 v[128:129], v178 offset:256
  ds_read_b64_tr_b16 v[130:131], v178 offset:2048
  ds_read_b64_tr_b16 v[132:133], v178 offset:320
  ds_read_b64_tr_b16 v[134:135], v178 offset:2112
  v_mfma_f32_32x32x16_bf16 v[48:63], v[152:155], v[172:175], v[48:63]
  ds_read_b64_tr_b16 v[136:137], v178 offset:384
  ds_read_b64_tr_b16 v[138:139], v178 offset:2176
  v_mfma_f32_32x32x16_bf16 v[64:79], v[156:159], v[172:175], v[64:79]
  v_mfma_f32_32x32x16_bf16 v[80:95], v[160:163], v[172:175], v[80:95]
  v_mfma_f32_32x32x16_bf16 v[96:111], v[164:167], v[172:175], v[96:111]
  s_waitcnt lgkmcnt(12)
  v_mfma_f32_32x32x16_bf16 v[0:15], v[112:115], v[168:171], v[0:15]
  ds_read_b128 v[172:175], v184
  ds_read_b64_tr_b16 v[140:141], v178 offset:7168
  ds_read_b64_tr_b16 v[142:143], v178 offset:8960
  s_waitcnt lgkmcnt(13)
  ds_read_b64_tr_b16 v[144:145], v178 offset:7232
  ds_read_b64_tr_b16 v[146:147], v178 offset:9024
  v_mfma_f32_32x32x16_bf16 v[16:31], v[116:119], v[168:171], v[16:31]
  s_waitcnt lgkmcnt(13)
  ds_read_b64_tr_b16 v[148:149], v178 offset:7296
  ds_read_b64_tr_b16 v[150:151], v178 offset:9088
  s_waitcnt lgkmcnt(13)
  ds_read_b64_tr_b16 v[152:153], v178 offset:7360
  ds_read_b64_tr_b16 v[154:155], v178 offset:9152
  v_mfma_f32_32x32x16_bf16 v[32:47], v[120:123], v[168:171], v[32:47]
  s_waitcnt lgkmcnt(13)
  ds_read_b64_tr_b16 v[156:157], v178 offset:7424
  ds_read_b64_tr_b16 v[158:159], v178 offset:9216
  s_waitcnt lgkmcnt(13)
  ds_read_b64_tr_b16 v[160:161], v178 offset:7488
  ds_read_b64_tr_b16 v[162:163], v178 offset:9280
  v_mfma_f32_32x32x16_bf16 v[48:63], v[124:127], v[168:171], v[48:63]
  s_waitcnt lgkmcnt(13)
  ds_read_b64_tr_b16 v[164:165], v178 offset:7552
  ds_read_b64_tr_b16 v[166:167], v178 offset:9344
  v_mfma_f32_32x32x16_bf16 v[64:79], v[128:131], v[168:171], v[64:79]
  v_mfma_f32_32x32x16_bf16 v[80:95], v[132:135], v[168:171], v[80:95]
  v_mfma_f32_32x32x16_bf16 v[96:111], v[136:139], v[168:171], v[96:111]
  s_waitcnt lgkmcnt(0)
  s_waitcnt vmcnt(7)
  s_barrier
  s_add_u32 s40, s39, 1769472
  s_mul_i32 s41, s25, 7168
  s_add_u32 m0, s41, 90112
  s_nop 0
  buffer_load_dwordx4 v185, s[8:11], s40 offen lds
  s_mul_i32 s41, s25, 7168
  s_add_u32 m0, s41, 91136
  s_nop 0
  buffer_load_dwordx4 v186, s[8:11], s40 offen lds
  s_mul_i32 s41, s25, 7168
  s_add_u32 m0, s41, 92160
  s_nop 0
  buffer_load_dwordx4 v187, s[8:11], s40 offen lds
  s_mul_i32 s41, s25, 7168
  s_add_u32 m0, s41, 93184
  s_nop 0
  buffer_load_dwordx4 v188, s[8:11], s40 offen lds
  s_mul_i32 s41, s25, 7168
  s_add_u32 m0, s41, 94208
  s_nop 0
  buffer_load_dwordx4 v189, s[8:11], s40 offen lds
  s_mul_i32 s41, s25, 7168
  s_add_u32 m0, s41, 95232
  s_nop 0
  buffer_load_dwordx4 v190, s[8:11], s40 offen lds
  s_mul_i32 s41, s25, 7168
  s_add_u32 m0, s41, 96256
  s_nop 0
  buffer_load_dwordx4 v191, s[8:11], s40 offen lds
  v_mfma_f32_32x32x16_bf16 v[0:15], v[140:143], v[172:175], v[0:15]
  ds_read_b128 v[168:171], v179
  ds_read_b64_tr_b16 v[112:113], v176 offset:0
  ds_read_b64_tr_b16 v[114:115], v176 offset:1792
  ds_read_b64_tr_b16 v[116:117], v176 offset:64
  ds_read_b64_tr_b16 v[118:119], v176 offset:1856
  v_mfma_f32_32x32x16_bf16 v[16:31], v[144:147], v[172:175], v[16:31]
  ds_read_b64_tr_b16 v[120:121], v176 offset:128
  ds_read_b64_tr_b16 v[122:123], v176 offset:1920
  ds_read_b64_tr_b16 v[124:125], v176 offset:192
  ds_read_b64_tr_b16 v[126:127], v176 offset:1984
  v_mfma_f32_32x32x16_bf16 v[32:47], v[148:151], v[172:175], v[32:47]
  ds_read_b64_tr_b16 v[128:129], v176 offset:256
  ds_read_b64_tr_b16 v[130:131], v176 offset:2048
  ds_read_b64_tr_b16 v[132:133], v176 offset:320
  ds_read_b64_tr_b16 v[134:135], v176 offset:2112
  v_mfma_f32_32x32x16_bf16 v[48:63], v[152:155], v[172:175], v[48:63]
  ds_read_b64_tr_b16 v[136:137], v176 offset:384
  ds_read_b64_tr_b16 v[138:139], v176 offset:2176
  v_mfma_f32_32x32x16_bf16 v[64:79], v[156:159], v[172:175], v[64:79]
  v_mfma_f32_32x32x16_bf16 v[80:95], v[160:163], v[172:175], v[80:95]
  v_mfma_f32_32x32x16_bf16 v[96:111], v[164:167], v[172:175], v[96:111]
  s_waitcnt lgkmcnt(12)
  v_mfma_f32_32x32x16_bf16 v[0:15], v[112:115], v[168:171], v[0:15]
  ds_read_b128 v[172:175], v182
  ds_read_b64_tr_b16 v[140:141], v176 offset:7168
  ds_read_b64_tr_b16 v[142:143], v176 offset:8960
  s_waitcnt lgkmcnt(13)
  ds_read_b64_tr_b16 v[144:145], v176 offset:7232
  ds_read_b64_tr_b16 v[146:147], v176 offset:9024
  v_mfma_f32_32x32x16_bf16 v[16:31], v[116:119], v[168:171], v[16:31]
  s_waitcnt lgkmcnt(13)
  ds_read_b64_tr_b16 v[148:149], v176 offset:7296
  ds_read_b64_tr_b16 v[150:151], v176 offset:9088
  s_waitcnt lgkmcnt(13)
  ds_read_b64_tr_b16 v[152:153], v176 offset:7360
  ds_read_b64_tr_b16 v[154:155], v176 offset:9152
  v_mfma_f32_32x32x16_bf16 v[32:47], v[120:123], v[168:171], v[32:47]
  s_waitcnt lgkmcnt(13)
  ds_read_b64_tr_b16 v[156:157], v176 offset:7424
  ds_read_b64_tr_b16 v[158:159], v176 offset:9216
  s_waitcnt lgkmcnt(13)
  ds_read_b64_tr_b16 v[160:161], v176 offset:7488
  ds_read_b64_tr_b16 v[162:163], v176 offset:9280
  v_mfma_f32_32x32x16_bf16 v[48:63], v[124:127], v[168:171], v[48:63]
  s_waitcnt lgkmcnt(13)
  ds_read_b64_tr_b16 v[164:165], v176 offset:7552
  ds_read_b64_tr_b16 v[166:167], v176 offset:9344
  v_mfma_f32_32x32x16_bf16 v[64:79], v[128:131], v[168:171], v[64:79]
  v_mfma_f32_32x32x16_bf16 v[80:95], v[132:135], v[168:171], v[80:95]
  v_mfma_f32_32x32x16_bf16 v[96:111], v[136:139], v[168:171], v[96:111]
  s_waitcnt lgkmcnt(0)
  s_waitcnt vmcnt(7)
  s_barrier
  v_mfma_f32_32x32x16_bf16 v[0:15], v[140:143], v[172:175], v[0:15]
  ds_read_b128 v[168:171], v180
  ds_read_b64_tr_b16 v[112:113], v177 offset:0
  ds_read_b64_tr_b16 v[114:115], v177 offset:1792
  ds_read_b64_tr_b16 v[116:117], v177 offset:64
  ds_read_b64_tr_b16 v[118:119], v177 offset:1856
  v_mfma_f32_32x32x16_bf16 v[16:31], v[144:147], v[172:175], v[16:31]
  ds_read_b64_tr_b16 v[120:121], v177 offset:128
  ds_read_b64_tr_b16 v[122:123], v177 offset:1920
  ds_read_b64_tr_b16 v[124:125], v177 offset:192
  ds_read_b64_tr_b16 v[126:127], v177 offset:1984
  v_mfma_f32_32x32x16_bf16 v[32:47], v[148:151], v[172:175], v[32:47]
  ds_read_b64_tr_b16 v[128:129], v177 offset:256
  ds_read_b64_tr_b16 v[130:131], v177 offset:2048
  ds_read_b64_tr_b16 v[132:133], v177 offset:320
  ds_read_b64_tr_b16 v[134:135], v177 offset:2112
  v_mfma_f32_32x32x16_bf16 v[48:63], v[152:155], v[172:175], v[48:63]
  ds_read_b64_tr_b16 v[136:137], v177 offset:384
  ds_read_b64_tr_b16 v[138:139], v177 offset:2176
  v_mfma_f32_32x32x16_bf16 v[64:79], v[156:159], v[172:175], v[64:79]
  v_mfma_f32_32x32x16_bf16 v[80:95], v[160:163], v[172:175], v[80:95]
  v_mfma_f32_32x32x16_bf16 v[96:111], v[164:167], v[172:175], v[96:111]
  s_waitcnt lgkmcnt(12)
  v_mfma_f32_32x32x16_bf16 v[0:15], v[112:115], v[168:171], v[0:15]
  ds_read_b128 v[172:175], v183
  ds_read_b64_tr_b16 v[140:141], v177 offset:7168
  ds_read_b64_tr_b16 v[142:143], v177 offset:8960
  s_waitcnt lgkmcnt(13)
  ds_read_b64_tr_b16 v[144:145], v177 offset:7232
  ds_read_b64_tr_b16 v[146:147], v177 offset:9024
  v_mfma_f32_32x32x16_bf16 v[16:31], v[116:119], v[168:171], v[16:31]
  s_waitcnt lgkmcnt(13)
  ds_read_b64_tr_b16 v[148:149], v177 offset:7296
  ds_read_b64_tr_b16 v[150:151], v177 offset:9088
  s_waitcnt lgkmcnt(13)
  ds_read_b64_tr_b16 v[152:153], v177 offset:7360
  ds_read_b64_tr_b16 v[154:155], v177 offset:9152
  v_mfma_f32_32x32x16_bf16 v[32:47], v[120:123], v[168:171], v[32:47]
  s_waitcnt lgkmcnt(13)
  ds_read_b64_tr_b16 v[156:157], v177 offset:7424
  ds_read_b64_tr_b16 v[158:159], v177 offset:9216
  s_waitcnt lgkmcnt(13)
  ds_read_b64_tr_b16 v[160:161], v177 offset:7488
  ds_read_b64_tr_b16 v[162:163], v177 offset:9280
  v_mfma_f32_32x32x16_bf16 v[48:63], v[124:127], v[168:171], v[48:63]
  s_waitcnt lgkmcnt(13)
  ds_read_b64_tr_b16 v[164:165], v177 offset:7552
  ds_read_b64_tr_b16 v[166:167], v177 offset:9344
  v_mfma_f32_32x32x16_bf16 v[64:79], v[128:131], v[168:171], v[64:79]
  v_mfma_f32_32x32x16_bf16 v[80:95], v[132:135], v[168:171], v[80:95]
  v_mfma_f32_32x32x16_bf16 v[96:111], v[136:139], v[168:171], v[96:111]
  s_waitcnt lgkmcnt(0)
  s_waitcnt vmcnt(0)
  s_barrier
  v_mfma_f32_32x32x16_bf16 v[0:15], v[140:143], v[172:175], v[0:15]
  ds_read_b128 v[168:171], v181
  ds_read_b64_tr_b16 v[112:113], v178 offset:0
  ds_read_b64_tr_b16 v[114:115], v178 offset:1792
  ds_read_b64_tr_b16 v[116:117], v178 offset:64
  ds_read_b64_tr_b16 v[118:119], v178 offset:1856
  v_mfma_f32_32x32x16_bf16 v[16:31], v[144:147], v[172:175], v[16:31]
  ds_read_b64_tr_b16 v[120:121], v178 offset:128
  ds_read_b64_tr_b16 v[122:123], v178 offset:1920
  ds_read_b64_tr_b16 v[124:125], v178 offset:192
  ds_read_b64_tr_b16 v[126:127], v178 offset:1984
  v_mfma_f32_32x32x16_bf16 v[32:47], v[148:151], v[172:175], v[32:47]
  ds_read_b64_tr_b16 v[128:129], v178 offset:256
  ds_read_b64_tr_b16 v[130:131], v178 offset:2048
  ds_read_b64_tr_b16 v[132:133], v178 offset:320
  ds_read_b64_tr_b16 v[134:135], v178 offset:2112
  v_mfma_f32_32x32x16_bf16 v[48:63], v[152:155], v[172:175], v[48:63]
  ds_read_b64_tr_b16 v[136:137], v178 offset:384
  ds_read_b64_tr_b16 v[138:139], v178 offset:2176
  v_mfma_f32_32x32x16_bf16 v[64:79], v[156:159], v[172:175], v[64:79]
  v_mfma_f32_32x32x16_bf16 v[80:95], v[160:163], v[172:175], v[80:95]
  v_mfma_f32_32x32x16_bf16 v[96:111], v[164:167], v[172:175], v[96:111]
  s_waitcnt lgkmcnt(12)
  v_mfma_f32_32x32x16_bf16 v[0:15], v[112:115], v[168:171], v[0:15]
  ds_read_b128 v[172:175], v184
  ds_read_b64_tr_b16 v[140:141], v178 offset:7168
  ds_read_b64_tr_b16 v[142:143], v178 offset:8960
  s_waitcnt lgkmcnt(13)
  ds_read_b64_tr_b16 v[144:145], v178 offset:7232
  ds_read_b64_tr_b16 v[146:147], v178 offset:9024
  v_mfma_f32_32x32x16_bf16 v[16:31], v[116:119], v[168:171], v[16:31]
  s_waitcnt lgkmcnt(13)
  ds_read_b64_tr_b16 v[148:149], v178 offset:7296
  ds_read_b64_tr_b16 v[150:151], v178 offset:9088
  s_waitcnt lgkmcnt(13)
  ds_read_b64_tr_b16 v[152:153], v178 offset:7360
  ds_read_b64_tr_b16 v[154:155], v178 offset:9152
  v_mfma_f32_32x32x16_bf16 v[32:47], v[120:123], v[168:171], v[32:47]
  s_waitcnt lgkmcnt(13)
  ds_read_b64_tr_b16 v[156:157], v178 offset:7424
  ds_read_b64_tr_b16 v[158:159], v178 offset:9216
  s_waitcnt lgkmcnt(13)
  ds_read_b64_tr_b16 v[160:161], v178 offset:7488
  ds_read_b64_tr_b16 v[162:163], v178 offset:9280
  v_mfma_f32_32x32x16_bf16 v[48:63], v[124:127], v[168:171], v[48:63]
  s_waitcnt lgkmcnt(13)
  ds_read_b64_tr_b16 v[164:165], v178 offset:7552
  ds_read_b64_tr_b16 v[166:167], v178 offset:9344
  v_mfma_f32_32x32x16_bf16 v[64:79], v[128:131], v[168:171], v[64:79]
  v_mfma_f32_32x32x16_bf16 v[80:95], v[132:135], v[168:171], v[80:95]
  v_mfma_f32_32x32x16_bf16 v[96:111], v[136:139], v[168:171], v[96:111]
  s_waitcnt lgkmcnt(0)
  s_barrier
  v_mfma_f32_32x32x16_bf16 v[0:15], v[140:143], v[172:175], v[0:15]
  v_mfma_f32_32x32x16_bf16 v[16:31], v[144:147], v[172:175], v[16:31]
  v_mfma_f32_32x32x16_bf16 v[32:47], v[148:151], v[172:175], v[32:47]
  v_mfma_f32_32x32x16_bf16 v[48:63], v[152:155], v[172:175], v[48:63]
  v_mfma_f32_32x32x16_bf16 v[64:79], v[156:159], v[172:175], v[64:79]
  v_mfma_f32_32x32x16_bf16 v[80:95], v[160:163], v[172:175], v[80:95]
  v_mfma_f32_32x32x16_bf16 v[96:111], v[164:167], v[172:175], v[96:111]
  s_barrier
  s_lshl_b32 s40, s25, 1
  s_add_u32 s41, s40, 1
  s_mul_i32 s41, s41, 15360
  s_add_u32 s40, s40, 0
  s_mul_i32 s40, s40, 15360
  v_lshlrev_b32 v193, 4, v192
  v_add_u32 v194, s41, v193
  v_add_u32 v195, s40, v193
  ds_write_b128 v194, v[16:19] offset:0
  ds_write_b128 v194, v[20:23] offset:1024
  ds_write_b128 v194, v[24:27] offset:2048
  ds_write_b128 v194, v[28:31] offset:3072
  ds_write_b128 v194, v[32:35] offset:4096
  ds_write_b128 v194, v[52:55] offset:5120
  ds_write_b128 v194, v[56:59] offset:6144
  ds_write_b128 v194, v[60:63] offset:7168
  ds_write_b128 v194, v[64:67] offset:8192
  ds_write_b128 v194, v[68:71] offset:9216
  ds_write_b128 v194, v[88:91] offset:10240
  ds_write_b128 v194, v[92:95] offset:11264
  ds_write_b128 v194, v[96:99] offset:12288
  ds_write_b128 v194, v[100:103] offset:13312
  ds_write_b128 v194, v[104:107] offset:14336
  s_waitcnt lgkmcnt(0)
  s_barrier
  ds_read_b128 v[112:115], v195 offset:0
  ds_read_b128 v[116:119], v195 offset:1024
  ds_read_b128 v[120:123], v195 offset:2048
  ds_read_b128 v[124:127], v195 offset:3072
  ds_read_b128 v[128:131], v195 offset:4096
  ds_read_b128 v[132:135], v195 offset:5120
  ds_read_b128 v[136:139], v195 offset:6144
  ds_read_b128 v[140:143], v195 offset:7168
  ds_read_b128 v[144:147], v195 offset:8192
  ds_read_b128 v[148:151], v195 offset:9216
  ds_read_b128 v[152:155], v195 offset:10240
  ds_read_b128 v[156:159], v195 offset:11264
  ds_read_b128 v[160:163], v195 offset:12288
  ds_read_b128 v[164:167], v195 offset:13312
  ds_read_b128 v[168:171], v195 offset:14336
  s_waitcnt lgkmcnt(14)
  v_add_f32 v0, v0, v112
  v_add_f32 v1, v1, v113
  v_add_f32 v2, v2, v114
  v_add_f32 v3, v3, v115
  s_waitcnt lgkmcnt(13)
  v_add_f32 v4, v4, v116
  v_add_f32 v5, v5, v117
  v_add_f32 v6, v6, v118
  v_add_f32 v7, v7, v119
  s_waitcnt lgkmcnt(12)
  v_add_f32 v8, v8, v120
  v_add_f32 v9, v9, v121
  v_add_f32 v10, v10, v122
  v_add_f32 v11, v11, v123
  s_waitcnt lgkmcnt(11)
  v_add_f32 v12, v12, v124
  v_add_f32 v13, v13, v125
  v_add_f32 v14, v14, v126
  v_add_f32 v15, v15, v127
  s_waitcnt lgkmcnt(10)
  v_add_f32 v16, v16, v128
  v_add_f32 v17, v17, v129
  v_add_f32 v18, v18, v130
  v_add_f32 v19, v19, v131
  s_waitcnt lgkmcnt(9)
  v_add_f32 v36, v36, v132
  v_add_f32 v37, v37, v133
  v_add_f32 v38, v38, v134
  v_add_f32 v39, v39, v135
  s_waitcnt lgkmcnt(8)
  v_add_f32 v40, v40, v136
  v_add_f32 v41, v41, v137
  v_add_f32 v42, v42, v138
  v_add_f32 v43, v43, v139
  s_waitcnt lgkmcnt(7)
  v_add_f32 v44, v44, v140
  v_add_f32 v45, v45, v141
  v_add_f32 v46, v46, v142
  v_add_f32 v47, v47, v143
  s_waitcnt lgkmcnt(6)
  v_add_f32 v48, v48, v144
  v_add_f32 v49, v49, v145
  v_add_f32 v50, v50, v146
  v_add_f32 v51, v51, v147
  s_waitcnt lgkmcnt(5)
  v_add_f32 v52, v52, v148
  v_add_f32 v53, v53, v149
  v_add_f32 v54, v54, v150
  v_add_f32 v55, v55, v151
  s_waitcnt lgkmcnt(4)
  v_add_f32 v72, v72, v152
  v_add_f32 v73, v73, v153
  v_add_f32 v74, v74, v154
  v_add_f32 v75, v75, v155
  s_waitcnt lgkmcnt(3)
  v_add_f32 v76, v76, v156
  v_add_f32 v77, v77, v157
  v_add_f32 v78, v78, v158
  v_add_f32 v79, v79, v159
  s_waitcnt lgkmcnt(2)
  v_add_f32 v80, v80, v160
  v_add_f32 v81, v81, v161
  v_add_f32 v82, v82, v162
  v_add_f32 v83, v83, v163
  s_waitcnt lgkmcnt(1)
  v_add_f32 v84, v84, v164
  v_add_f32 v85, v85, v165
  v_add_f32 v86, v86, v166
  v_add_f32 v87, v87, v167
  s_waitcnt lgkmcnt(0)
  v_add_f32 v88, v88, v168
  v_add_f32 v89, v89, v169
  v_add_f32 v90, v90, v170
  v_add_f32 v91, v91, v171
  s_cmp_eq_u32 s29, 0
  s_cbranch_scc0 k1_epb0
  v_cvt_pk_bf16_f32 v112, v0, v1
  v_cvt_pk_bf16_f32 v113, v2, v3
  v_cvt_pk_bf16_f32 v114, v4, v5
  v_cvt_pk_bf16_f32 v115, v6, v7
  v_cvt_pk_bf16_f32 v116, v8, v9
  v_cvt_pk_bf16_f32 v117, v10, v11
  v_cvt_pk_bf16_f32 v118, v12, v13
  v_cvt_pk_bf16_f32 v119, v14, v15
  v_cvt_pk_bf16_f32 v120, v16, v17
  v_cvt_pk_bf16_f32 v121, v18, v19
  v_cvt_pk_bf16_f32 v122, v36, v37
  v_cvt_pk_bf16_f32 v123, v38, v39
  v_cvt_pk_bf16_f32 v124, v40, v41
  v_cvt_pk_bf16_f32 v125, v42, v43
  v_cvt_pk_bf16_f32 v126, v44, v45
  v_cvt_pk_bf16_f32 v127, v46, v47
  v_cvt_pk_bf16_f32 v128, v48, v49
  v_cvt_pk_bf16_f32 v129, v50, v51
  v_cvt_pk_bf16_f32 v130, v52, v53
  v_cvt_pk_bf16_f32 v131, v54, v55
  v_cvt_pk_bf16_f32 v132, v72, v73
  v_cvt_pk_bf16_f32 v133, v74, v75
  v_cvt_pk_bf16_f32 v134, v76, v77
  v_cvt_pk_bf16_f32 v135, v78, v79
  v_cvt_pk_bf16_f32 v136, v80, v81
  v_cvt_pk_bf16_f32 v137, v82, v83
  v_cvt_pk_bf16_f32 v138, v84, v85
  v_cvt_pk_bf16_f32 v139, v86, v87
  v_cvt_pk_bf16_f32 v140, v88, v89
  v_cvt_pk_bf16_f32 v141, v90, v91
  v_lshlrev_b32 v162, 16, v112
  v_and_b32 v163, 0xffff0000, v112
  v_min_f32 v164, 0, v162
  v_min_f32 v165, 0, v163
  v_mul_f32 v164, 0x3fb8aa3b, v164
  v_mul_f32 v165, 0x3fb8aa3b, v165
  v_exp_f32 v164, v164
  v_exp_f32 v165, v165
  v_max_f32 v162, 0, v162
  v_max_f32 v163, 0, v163
  v_add_f32 v162, v162, v164
  v_add_f32 v163, v163, v165
  v_cvt_pk_bf16_f32 v164, v162, v163
  v_lshlrev_b32 v162, 16, v164
  v_and_b32 v163, 0xffff0000, v164
  v_add_f32 v162, 0x358637bd, v162
  v_add_f32 v163, 0x358637bd, v163
  v_cvt_pk_bf16_f32 v142, v162, v163
  v_lshlrev_b32 v166, 16, v113
  v_and_b32 v167, 0xffff0000, v113
  v_min_f32 v168, 0, v166
  v_min_f32 v169, 0, v167
  v_mul_f32 v168, 0x3fb8aa3b, v168
  v_mul_f32 v169, 0x3fb8aa3b, v169
  v_exp_f32 v168, v168
  v_exp_f32 v169, v169
  v_max_f32 v166, 0, v166
  v_max_f32 v167, 0, v167
  v_add_f32 v166, v166, v168
  v_add_f32 v167, v167, v169
  v_cvt_pk_bf16_f32 v168, v166, v167
  v_lshlrev_b32 v166, 16, v168
  v_and_b32 v167, 0xffff0000, v168
  v_add_f32 v166, 0x358637bd, v166
  v_add_f32 v167, 0x358637bd, v167
  v_cvt_pk_bf16_f32 v143, v166, v167
  v_lshlrev_b32 v162, 16, v114
  v_and_b32 v163, 0xffff0000, v114
  v_min_f32 v164, 0, v162
  v_min_f32 v165, 0, v163
  v_mul_f32 v164, 0x3fb8aa3b, v164
  v_mul_f32 v165, 0x3fb8aa3b, v165
  v_exp_f32 v164, v164
  v_exp_f32 v165, v165
  v_max_f32 v162, 0, v162
  v_max_f32 v163, 0, v163
  v_add_f32 v162, v162, v164
  v_add_f32 v163, v163, v165
  v_cvt_pk_bf16_f32 v164, v162, v163
  v_lshlrev_b32 v162, 16, v164
  v_and_b32 v163, 0xffff0000, v164
  v_add_f32 v162, 0x358637bd, v162
  v_add_f32 v163, 0x358637bd, v163
  v_cvt_pk_bf16_f32 v144, v162, v163
  v_lshlrev_b32 v166, 16, v115
  v_and_b32 v167, 0xffff0000, v115
  v_min_f32 v168, 0, v166
  v_min_f32 v169, 0, v167
  v_mul_f32 v168, 0x3fb8aa3b, v168
  v_mul_f32 v169, 0x3fb8aa3b, v169
  v_exp_f32 v168, v168
  v_exp_f32 v169, v169
  v_max_f32 v166, 0, v166
  v_max_f32 v167, 0, v167
  v_add_f32 v166, v166, v168
  v_add_f32 v167, v167, v169
  v_cvt_pk_bf16_f32 v168, v166, v167
  v_lshlrev_b32 v166, 16, v168
  v_and_b32 v167, 0xffff0000, v168
  v_add_f32 v166, 0x358637bd, v166
  v_add_f32 v167, 0x358637bd, v167
  v_cvt_pk_bf16_f32 v145, v166, v167
  v_lshlrev_b32 v162, 16, v116
  v_and_b32 v163, 0xffff0000, v116
  v_min_f32 v164, 0, v162
  v_min_f32 v165, 0, v163
  v_mul_f32 v164, 0x3fb8aa3b, v164
  v_mul_f32 v165, 0x3fb8aa3b, v165
  v_exp_f32 v164, v164
  v_exp_f32 v165, v165
  v_max_f32 v162, 0, v162
  v_max_f32 v163, 0, v163
  v_add_f32 v162, v162, v164
  v_add_f32 v163, v163, v165
  v_cvt_pk_bf16_f32 v164, v162, v163
  v_lshlrev_b32 v162, 16, v164
  v_and_b32 v163, 0xffff0000, v164
  v_add_f32 v162, 0x358637bd, v162
  v_add_f32 v163, 0x358637bd, v163
  v_cvt_pk_bf16_f32 v146, v162, v163
  v_lshlrev_b32 v166, 16, v117
  v_and_b32 v167, 0xffff0000, v117
  v_min_f32 v168, 0, v166
  v_min_f32 v169, 0, v167
  v_mul_f32 v168, 0x3fb8aa3b, v168
  v_mul_f32 v169, 0x3fb8aa3b, v169
  v_exp_f32 v168, v168
  v_exp_f32 v169, v169
  v_max_f32 v166, 0, v166
  v_max_f32 v167, 0, v167
  v_add_f32 v166, v166, v168
  v_add_f32 v167, v167, v169
  v_cvt_pk_bf16_f32 v168, v166, v167
  v_lshlrev_b32 v166, 16, v168
  v_and_b32 v167, 0xffff0000, v168
  v_add_f32 v166, 0x358637bd, v166
  v_add_f32 v167, 0x358637bd, v167
  v_cvt_pk_bf16_f32 v147, v166, v167
  v_lshlrev_b32 v162, 16, v118
  v_and_b32 v163, 0xffff0000, v118
  v_min_f32 v164, 0, v162
  v_min_f32 v165, 0, v163
  v_mul_f32 v164, 0x3fb8aa3b, v164
  v_mul_f32 v165, 0x3fb8aa3b, v165
  v_exp_f32 v164, v164
  v_exp_f32 v165, v165
  v_max_f32 v162, 0, v162
  v_max_f32 v163, 0, v163
  v_add_f32 v162, v162, v164
  v_add_f32 v163, v163, v165
  v_cvt_pk_bf16_f32 v164, v162, v163
  v_lshlrev_b32 v162, 16, v164
  v_and_b32 v163, 0xffff0000, v164
  v_add_f32 v162, 0x358637bd, v162
  v_add_f32 v163, 0x358637bd, v163
  v_cvt_pk_bf16_f32 v148, v162, v163
  v_lshlrev_b32 v166, 16, v119
  v_and_b32 v167, 0xffff0000, v119
  v_min_f32 v168, 0, v166
  v_min_f32 v169, 0, v167
  v_mul_f32 v168, 0x3fb8aa3b, v168
  v_mul_f32 v169, 0x3fb8aa3b, v169
  v_exp_f32 v168, v168
  v_exp_f32 v169, v169
  v_max_f32 v166, 0, v166
  v_max_f32 v167, 0, v167
  v_add_f32 v166, v166, v168
  v_add_f32 v167, v167, v169
  v_cvt_pk_bf16_f32 v168, v166, v167
  v_lshlrev_b32 v166, 16, v168
  v_and_b32 v167, 0xffff0000, v168
  v_add_f32 v166, 0x358637bd, v166
  v_add_f32 v167, 0x358637bd, v167
  v_cvt_pk_bf16_f32 v149, v166, v167
  v_lshlrev_b32 v162, 16, v120
  v_and_b32 v163, 0xffff0000, v120
  v_min_f32 v164, 0, v162
  v_min_f32 v165, 0, v163
  v_mul_f32 v164, 0x3fb8aa3b, v164
  v_mul_f32 v165, 0x3fb8aa3b, v165
  v_exp_f32 v164, v164
  v_exp_f32 v165, v165
  v_max_f32 v162, 0, v162
  v_max_f32 v163, 0, v163
  v_add_f32 v162, v162, v164
  v_add_f32 v163, v163, v165
  v_cvt_pk_bf16_f32 v164, v162, v163
  v_lshlrev_b32 v162, 16, v164
  v_and_b32 v163, 0xffff0000, v164
  v_add_f32 v162, 0x358637bd, v162
  v_add_f32 v163, 0x358637bd, v163
  v_cvt_pk_bf16_f32 v150, v162, v163
  v_lshlrev_b32 v166, 16, v121
  v_and_b32 v167, 0xffff0000, v121
  v_min_f32 v168, 0, v166
  v_min_f32 v169, 0, v167
  v_mul_f32 v168, 0x3fb8aa3b, v168
  v_mul_f32 v169, 0x3fb8aa3b, v169
  v_exp_f32 v168, v168
  v_exp_f32 v169, v169
  v_max_f32 v166, 0, v166
  v_max_f32 v167, 0, v167
  v_add_f32 v166, v166, v168
  v_add_f32 v167, v167, v169
  v_cvt_pk_bf16_f32 v168, v166, v167
  v_lshlrev_b32 v166, 16, v168
  v_and_b32 v167, 0xffff0000, v168
  v_add_f32 v166, 0x358637bd, v166
  v_add_f32 v167, 0x358637bd, v167
  v_cvt_pk_bf16_f32 v151, v166, v167
  v_lshlrev_b32 v162, 16, v122
  v_and_b32 v163, 0xffff0000, v122
  v_min_f32 v164, 0, v162
  v_min_f32 v165, 0, v163
  v_mul_f32 v164, 0x3fb8aa3b, v164
  v_mul_f32 v165, 0x3fb8aa3b, v165
  v_exp_f32 v164, v164
  v_exp_f32 v165, v165
  v_max_f32 v162, 0, v162
  v_max_f32 v163, 0, v163
  v_add_f32 v162, v162, v164
  v_add_f32 v163, v163, v165
  v_cvt_pk_bf16_f32 v164, v162, v163
  v_lshlrev_b32 v162, 16, v164
  v_and_b32 v163, 0xffff0000, v164
  v_add_f32 v162, 0x358637bd, v162
  v_add_f32 v163, 0x358637bd, v163
  v_cvt_pk_bf16_f32 v152, v162, v163
  v_lshlrev_b32 v166, 16, v123
  v_and_b32 v167, 0xffff0000, v123
  v_min_f32 v168, 0, v166
  v_min_f32 v169, 0, v167
  v_mul_f32 v168, 0x3fb8aa3b, v168
  v_mul_f32 v169, 0x3fb8aa3b, v169
  v_exp_f32 v168, v168
  v_exp_f32 v169, v169
  v_max_f32 v166, 0, v166
  v_max_f32 v167, 0, v167
  v_add_f32 v166, v166, v168
  v_add_f32 v167, v167, v169
  v_cvt_pk_bf16_f32 v168, v166, v167
  v_lshlrev_b32 v166, 16, v168
  v_and_b32 v167, 0xffff0000, v168
  v_add_f32 v166, 0x358637bd, v166
  v_add_f32 v167, 0x358637bd, v167
  v_cvt_pk_bf16_f32 v153, v166, v167
  v_lshlrev_b32 v162, 16, v124
  v_and_b32 v163, 0xffff0000, v124
  v_min_f32 v164, 0, v162
  v_min_f32 v165, 0, v163
  v_mul_f32 v164, 0x3fb8aa3b, v164
  v_mul_f32 v165, 0x3fb8aa3b, v165
  v_exp_f32 v164, v164
  v_exp_f32 v165, v165
  v_max_f32 v162, 0, v162
  v_max_f32 v163, 0, v163
  v_add_f32 v162, v162, v164
  v_add_f32 v163, v163, v165
  v_cvt_pk_bf16_f32 v164, v162, v163
  v_lshlrev_b32 v162, 16, v164
  v_and_b32 v163, 0xffff0000, v164
  v_add_f32 v162, 0x358637bd, v162
  v_add_f32 v163, 0x358637bd, v163
  v_cvt_pk_bf16_f32 v154, v162, v163
  v_lshlrev_b32 v166, 16, v125
  v_and_b32 v167, 0xffff0000, v125
  v_min_f32 v168, 0, v166
  v_min_f32 v169, 0, v167
  v_mul_f32 v168, 0x3fb8aa3b, v168
  v_mul_f32 v169, 0x3fb8aa3b, v169
  v_exp_f32 v168, v168
  v_exp_f32 v169, v169
  v_max_f32 v166, 0, v166
  v_max_f32 v167, 0, v167
  v_add_f32 v166, v166, v168
  v_add_f32 v167, v167, v169
  v_cvt_pk_bf16_f32 v168, v166, v167
  v_lshlrev_b32 v166, 16, v168
  v_and_b32 v167, 0xffff0000, v168
  v_add_f32 v166, 0x358637bd, v166
  v_add_f32 v167, 0x358637bd, v167
  v_cvt_pk_bf16_f32 v155, v166, v167
  v_lshlrev_b32 v162, 16, v126
  v_and_b32 v163, 0xffff0000, v126
  v_min_f32 v164, 0, v162
  v_min_f32 v165, 0, v163
  v_mul_f32 v164, 0x3fb8aa3b, v164
  v_mul_f32 v165, 0x3fb8aa3b, v165
  v_exp_f32 v164, v164
  v_exp_f32 v165, v165
  v_max_f32 v162, 0, v162
  v_max_f32 v163, 0, v163
  v_add_f32 v162, v162, v164
  v_add_f32 v163, v163, v165
  v_cvt_pk_bf16_f32 v164, v162, v163
  v_lshlrev_b32 v162, 16, v164
  v_and_b32 v163, 0xffff0000, v164
  v_add_f32 v162, 0x358637bd, v162
  v_add_f32 v163, 0x358637bd, v163
  v_cvt_pk_bf16_f32 v156, v162, v163
  v_lshlrev_b32 v166, 16, v127
  v_and_b32 v167, 0xffff0000, v127
  v_min_f32 v168, 0, v166
  v_min_f32 v169, 0, v167
  v_mul_f32 v168, 0x3fb8aa3b, v168
  v_mul_f32 v169, 0x3fb8aa3b, v169
  v_exp_f32 v168, v168
  v_exp_f32 v169, v169
  v_max_f32 v166, 0, v166
  v_max_f32 v167, 0, v167
  v_add_f32 v166, v166, v168
  v_add_f32 v167, v167, v169
  v_cvt_pk_bf16_f32 v168, v166, v167
  v_lshlrev_b32 v166, 16, v168
  v_and_b32 v167, 0xffff0000, v168
  v_add_f32 v166, 0x358637bd, v166
  v_add_f32 v167, 0x358637bd, v167
  v_cvt_pk_bf16_f32 v157, v166, v167
  v_lshlrev_b32 v162, 16, v128
  v_and_b32 v163, 0xffff0000, v128
  v_min_f32 v164, 0, v162
  v_min_f32 v165, 0, v163
  v_mul_f32 v164, 0x3fb8aa3b, v164
  v_mul_f32 v165, 0x3fb8aa3b, v165
  v_exp_f32 v164, v164
  v_exp_f32 v165, v165
  v_max_f32 v162, 0, v162
  v_max_f32 v163, 0, v163
  v_add_f32 v162, v162, v164
  v_add_f32 v163, v163, v165
  v_cvt_pk_bf16_f32 v164, v162, v163
  v_lshlrev_b32 v162, 16, v164
  v_and_b32 v163, 0xffff0000, v164
  v_add_f32 v162, 0x358637bd, v162
  v_add_f32 v163, 0x358637bd, v163
  v_cvt_pk_bf16_f32 v158, v162, v163
  v_lshlrev_b32 v166, 16, v129
  v_and_b32 v167, 0xffff0000, v129
  v_min_f32 v168, 0, v166
  v_min_f32 v169, 0, v167
  v_mul_f32 v168, 0x3fb8aa3b, v168
  v_mul_f32 v169, 0x3fb8aa3b, v169
  v_exp_f32 v168, v168
  v_exp_f32 v169, v169
  v_max_f32 v166, 0, v166
  v_max_f32 v167, 0, v167
  v_add_f32 v166, v166, v168
  v_add_f32 v167, v167, v169
  v_cvt_pk_bf16_f32 v168, v166, v167
  v_lshlrev_b32 v166, 16, v168
  v_and_b32 v167, 0xffff0000, v168
  v_add_f32 v166, 0x358637bd, v166
  v_add_f32 v167, 0x358637bd, v167
  v_cvt_pk_bf16_f32 v159, v166, v167
  v_lshlrev_b32 v162, 16, v130
  v_and_b32 v163, 0xffff0000, v130
  v_min_f32 v164, 0, v162
  v_min_f32 v165, 0, v163
  v_mul_f32 v164, 0x3fb8aa3b, v164
  v_mul_f32 v165, 0x3fb8aa3b, v165
  v_exp_f32 v164, v164
  v_exp_f32 v165, v165
  v_max_f32 v162, 0, v162
  v_max_f32 v163, 0, v163
  v_add_f32 v162, v162, v164
  v_add_f32 v163, v163, v165
  v_cvt_pk_bf16_f32 v164, v162, v163
  v_lshlrev_b32 v162, 16, v164
  v_and_b32 v163, 0xffff0000, v164
  v_add_f32 v162, 0x358637bd, v162
  v_add_f32 v163, 0x358637bd, v163
  v_cvt_pk_bf16_f32 v160, v162, v163
  v_lshlrev_b32 v166, 16, v131
  v_and_b32 v167, 0xffff0000, v131
  v_min_f32 v168, 0, v166
  v_min_f32 v169, 0, v167
  v_mul_f32 v168, 0x3fb8aa3b, v168
  v_mul_f32 v169, 0x3fb8aa3b, v169
  v_exp_f32 v168, v168
  v_exp_f32 v169, v169
  v_max_f32 v166, 0, v166
  v_max_f32 v167, 0, v167
  v_add_f32 v166, v166, v168
  v_add_f32 v167, v167, v169
  v_cvt_pk_bf16_f32 v168, v166, v167
  v_lshlrev_b32 v166, 16, v168
  v_and_b32 v167, 0xffff0000, v168
  v_add_f32 v166, 0x358637bd, v166
  v_add_f32 v167, 0x358637bd, v167
  v_cvt_pk_bf16_f32 v161, v166, v167
  s_lshl_b32 s40, s27, 2
  s_add_u32 s40, s40, s25
  s_lshl_b32 s40, s40, 3
  s_add_u32 s40, s40, s30
  s_mul_i32 s40, s40, 5120
  s_add_u32 s40, s40, 0
  v_lshlrev_b32 v162, 4, v192
  buffer_store_dwordx4 v[142:145], v162, s[16:19], s40 offen offset:0 sc0 sc1
  buffer_store_dwordx4 v[146:149], v162, s[16:19], s40 offen offset:1024 sc0 sc1
  s_barrier
  v_and_b32 v162, 31, v192
  v_lshrrev_b32 v163, 5, v192
  s_lshl_b32 s40, s25, 5
  v_add_u32 v162, s40, v162
  v_mul_u32_u24 v162, 328, v162
  v_lshl_add_u32 v190, v163, 3, v162
  v_mul_u32_u24 v163, 12, v163
  v_add_u32 v191, v163, v162
  ds_write_b64 v190, v[152:153] offset:0
  ds_write_b64 v190, v[154:155] offset:16
  ds_write_b64 v190, v[156:157] offset:32
  ds_write_b64 v190, v[158:159] offset:48
  ds_write_b64 v190, v[160:161] offset:64
  ds_write_b32 v190, v132 offset:144
  ds_write_b32 v190, v133 offset:148
  ds_write_b32 v190, v134 offset:160
  ds_write_b32 v190, v135 offset:164
  ds_write_b32 v191, v136 offset:176
  ds_write_b32 v190, v137 offset:184
  ds_write_b32 v190, v138 offset:196
  ds_write_b32 v190, v139 offset:200
  ds_write_b32 v191, v140 offset:212
  ds_write_b32 v191, v141 offset:216
  s_waitcnt lgkmcnt(0)
  s_barrier
  s_lshl_b32 s42, s25, 4
  s_mul_i32 s43, s25, 20
  s_add_u32 s43, s43, 72
  s_lshl_b32 s46, s30, 2
  s_add_u32 s46, s46, s25
  v_lshrrev_b32 v162, 5, v192
  v_lshrrev_b32 v163, 4, v192
  v_and_b32 v163, 1, v163
  v_and_b32 v164, 15, v192
  v_lshrrev_b32 v165, 2, v164
  v_and_b32 v166, 3, v164
  v_lshl_add_u32 v167, v162, 3, v165
  v_mul_u32_u24 v167, 328, v167
  v_lshlrev_b32 v168, 5, v163
  v_lshl_add_u32 v168, v166, 3, v168
  v_add_u32 v167, v167, v168
  s_lshl_b32 s42, s42, 1
  s_lshl_b32 s43, s43, 1
  v_add_u32 v168, s42, v167
  v_add_u32 v169, s43, v167
  v_add_u32 v170, 20992, v168
  v_add_u32 v171, 20992, v169
  v_mov_b32 v172, 0x3f803f80
  s_mov_b32 s44, 0x00440000
  s_mov_b32 s45, 0x00440000
  ds_read_b64_tr_b16 v[0:1], v168 offset:0
  ds_read_b64_tr_b16 v[32:33], v169 offset:0
  ds_read_b64_tr_b16 v[2:3], v168 offset:1312
  ds_read_b64_tr_b16 v[34:35], v169 offset:1312
  ds_read_b64_tr_b16 v[4:5], v168 offset:5248
  ds_read_b64_tr_b16 v[36:37], v169 offset:5248
  ds_read_b64_tr_b16 v[6:7], v168 offset:6560
  ds_read_b64_tr_b16 v[38:39], v169 offset:6560
  ds_read_b64_tr_b16 v[8:9], v168 offset:10496
  ds_read_b64_tr_b16 v[40:41], v169 offset:10496
  ds_read_b64_tr_b16 v[10:11], v168 offset:11808
  ds_read_b64_tr_b16 v[42:43], v169 offset:11808
  ds_read_b64_tr_b16 v[12:13], v168 offset:15744
  ds_read_b64_tr_b16 v[44:45], v169 offset:15744
  ds_read_b64_tr_b16 v[14:15], v168 offset:17056
  s_waitcnt lgkmcnt(13)
  ds_read_b64_tr_b16 v[46:47], v169 offset:17056
  ds_read_b64_tr_b16 v[16:17], v170 offset:0
  s_waitcnt lgkmcnt(13)
  ds_read_b64_tr_b16 v[48:49], v171 offset:0
  ds_read_b64_tr_b16 v[18:19], v170 offset:1312
  s_waitcnt lgkmcnt(13)
  ds_read_b64_tr_b16 v[50:51], v171 offset:1312
  ds_read_b64_tr_b16 v[20:21], v170 offset:5248
  s_waitcnt lgkmcnt(13)
  ds_read_b64_tr_b16 v[52:53], v171 offset:5248
  ds_read_b64_tr_b16 v[22:23], v170 offset:6560
  s_waitcnt lgkmcnt(13)
  ds_read_b64_tr_b16 v[54:55], v171 offset:6560
  ds_read_b64_tr_b16 v[24:25], v170 offset:10496
  s_waitcnt lgkmcnt(13)
  ds_read_b64_tr_b16 v[56:57], v171 offset:10496
  ds_read_b64_tr_b16 v[26:27], v170 offset:11808
  s_waitcnt lgkmcnt(13)
  ds_read_b64_tr_b16 v[58:59], v171 offset:11808
  ds_read_b64_tr_b16 v[28:29], v170 offset:15744
  s_waitcnt lgkmcnt(13)
  ds_read_b64_tr_b16 v[60:61], v171 offset:15744
  ds_read_b64_tr_b16 v[30:31], v170 offset:17056
  s_waitcnt lgkmcnt(13)
  ds_read_b64_tr_b16 v[62:63], v171 offset:17056
  v_cndmask_b32 v32, v32, v172, s[44:45]
  v_cndmask_b32 v33, v33, v172, s[44:45]
  v_cndmask_b32 v34, v34, v172, s[44:45]
  v_cndmask_b32 v35, v35, v172, s[44:45]
  s_nop 1
  v_mfma_f32_32x32x16_bf16 v[64:79], v[0:3], v[32:35], 0
  v_cndmask_b32 v36, v36, v172, s[44:45]
  v_cndmask_b32 v37, v37, v172, s[44:45]
  v_cndmask_b32 v38, v38, v172, s[44:45]
  v_cndmask_b32 v39, v39, v172, s[44:45]
  s_nop 1
  v_mfma_f32_32x32x16_bf16 v[64:79], v[4:7], v[36:39], v[64:79]
  v_cndmask_b32 v40, v40, v172, s[44:45]
  v_cndmask_b32 v41, v41, v172, s[44:45]
  v_cndmask_b32 v42, v42, v172, s[44:45]
  v_cndmask_b32 v43, v43, v172, s[44:45]
  s_nop 1
  v_mfma_f32_32x32x16_bf16 v[64:79], v[8:11], v[40:43], v[64:79]
  v_cndmask_b32 v44, v44, v172, s[44:45]
  v_cndmask_b32 v45, v45, v172, s[44:45]
  v_cndmask_b32 v46, v46, v172, s[44:45]
  v_cndmask_b32 v47, v47, v172, s[44:45]
  s_nop 1
  v_mfma_f32_32x32x16_bf16 v[64:79], v[12:15], v[44:47], v[64:79]
  v_cndmask_b32 v48, v48, v172, s[44:45]
  v_cndmask_b32 v49, v49, v172, s[44:45]
  s_waitcnt lgkmcnt(12)
  v_cndmask_b32 v50, v50, v172, s[44:45]
  v_cndmask_b32 v51, v51, v172, s[44:45]
  s_nop 1
  v_mfma_f32_32x32x16_bf16 v[64:79], v[16:19], v[48:51], v[64:79]
  s_waitcnt lgkmcnt(10)
  v_cndmask_b32 v52, v52, v172, s[44:45]
  v_cndmask_b32 v53, v53, v172, s[44:45]
  s_waitcnt lgkmcnt(8)
  v_cndmask_b32 v54, v54, v172, s[44:45]
  v_cndmask_b32 v55, v55, v172, s[44:45]
  s_nop 1
  v_mfma_f32_32x32x16_bf16 v[64:79], v[20:23], v[52:55], v[64:79]
  s_waitcnt lgkmcnt(6)
  v_cndmask_b32 v56, v56, v172, s[44:45]
  v_cndmask_b32 v57, v57, v172, s[44:45]
  s_waitcnt lgkmcnt(4)
  v_cndmask_b32 v58, v58, v172, s[44:45]
  v_cndmask_b32 v59, v59, v172, s[44:45]
  s_nop 1
  v_mfma_f32_32x32x16_bf16 v[64:79], v[24:27], v[56:59], v[64:79]
  s_waitcnt lgkmcnt(2)
  v_cndmask_b32 v60, v60, v172, s[44:45]
  v_cndmask_b32 v61, v61, v172, s[44:45]
  s_waitcnt lgkmcnt(0)
  v_cndmask_b32 v62, v62, v172, s[44:45]
  v_cndmask_b32 v63, v63, v172, s[44:45]
  s_nop 1
  v_mfma_f32_32x32x16_bf16 v[64:79], v[28:31], v[60:63], v[64:79]
  s_mul_i32 s40, s27, 96
  s_add_u32 s40, s40, s46
  s_mul_i32 s40, s40, 3072
  s_add_u32 s40, s40, 7340032
  v_lshlrev_b32 v162, 4, v192
  s_nop 6
  buffer_store_dwordx4 v[64:67], v162, s[16:19], s40 offen offset:0 sc0 sc1
  buffer_store_dwordx4 v[68:71], v162, s[16:19], s40 offen offset:1024 sc0 sc1
  buffer_store_dwordx4 v[72:75], v162, s[16:19], s40 offen offset:2048 sc0 sc1
  s_endpgm
k1_epb0:
  s_waitcnt vmcnt(0)
  s_nop 15
  s_nop 7
  v_cvt_pk_bf16_f32 v112, v0, v1
  v_cvt_pk_bf16_f32 v113, v2, v3
  v_cvt_pk_bf16_f32 v114, v4, v5
  v_cvt_pk_bf16_f32 v115, v6, v7
  v_cvt_pk_bf16_f32 v116, v8, v9
  v_cvt_pk_bf16_f32 v117, v10, v11
  v_cvt_pk_bf16_f32 v118, v12, v13
  v_cvt_pk_bf16_f32 v119, v14, v15
  v_cvt_pk_bf16_f32 v120, v16, v17
  v_cvt_pk_bf16_f32 v121, v18, v19
  v_cvt_pk_bf16_f32 v122, v36, v37
  v_cvt_pk_bf16_f32 v123, v38, v39
  v_cvt_pk_bf16_f32 v124, v40, v41
  v_cvt_pk_bf16_f32 v125, v42, v43
  v_cvt_pk_bf16_f32 v126, v44, v45
  v_cvt_pk_bf16_f32 v127, v46, v47
  v_cvt_pk_bf16_f32 v128, v48, v49
  v_cvt_pk_bf16_f32 v129, v50, v51
  v_cvt_pk_bf16_f32 v130, v52, v53
  v_cvt_pk_bf16_f32 v131, v54, v55
  v_cvt_pk_bf16_f32 v132, v72, v73
  v_cvt_pk_bf16_f32 v133, v74, v75
  v_cvt_pk_bf16_f32 v134, v76, v77
  v_cvt_pk_bf16_f32 v135, v78, v79
  v_cvt_pk_bf16_f32 v136, v80, v81
  v_cvt_pk_bf16_f32 v137, v82, v83
  v_cvt_pk_bf16_f32 v138, v84, v85
  v_cvt_pk_bf16_f32 v139, v86, v87
  v_cvt_pk_bf16_f32 v140, v88, v89
  v_cvt_pk_bf16_f32 v141, v90, v91
  v_lshl_or_b32 v240, v209, 16, v208
  v_lshl_or_b32 v241, v211, 16, v210
  v_lshl_or_b32 v242, v213, 16, v212
  v_lshl_or_b32 v243, v215, 16, v214
  v_lshl_or_b32 v244, v217, 16, v216
  v_lshl_or_b32 v245, v219, 16, v218
  v_lshl_or_b32 v246, v221, 16, v220
  v_lshl_or_b32 v247, v223, 16, v222
  v_lshl_or_b32 v248, v225, 16, v224
  v_lshl_or_b32 v249, v227, 16, v226
  v_lshl_or_b32 v250, v229, 16, v228
  v_lshl_or_b32 v251, v231, 16, v230
  v_lshl_or_b32 v252, v233, 16, v232
  v_lshl_or_b32 v253, v235, 16, v234
  v_lshl_or_b32 v254, v237, 16, v236
  v_lshl_or_b32 v255, v239, 16, v238
  s_lshl_b32 s40, s27, 2
  s_add_u32 s40, s40, s25
  s_lshl_b32 s40, s40, 5
  s_lshl_b32 s41, s30, 2
  s_add_u32 s40, s40, s41
  v_lshlrev_b32 v56, 4, v192
  v_lshlrev_b32 v57, 2, v192
  v_mfma_f32_32x32x16_bf16 v[0:15], v[240:243], v[112:115], 0
  v_mfma_f32_32x32x16_bf16 v[0:15], v[244:247], v[116:119], v[0:15]
  s_nop 11
  v_cvt_pk_bf16_f32 v171, v0, v1
  v_cvt_pk_bf16_f32 v172, v2, v3
  v_cvt_pk_bf16_f32 v173, v4, v5
  v_cvt_pk_bf16_f32 v174, v6, v7
  v_cvt_pk_bf16_f32 v175, v8, v8
  v_lshlrev_b32 v162, 16, v171
  v_and_b32 v163, 0xffff0000, v171
  v_lshlrev_b32 v164, 16, v172
  v_and_b32 v165, 0xffff0000, v172
  v_lshlrev_b32 v166, 16, v173
  v_and_b32 v167, 0xffff0000, v173
  v_lshlrev_b32 v168, 16, v174
  v_and_b32 v169, 0xffff0000, v174
  v_lshlrev_b32 v170, 16, v175
  v_max3_f32 v176, v162, v163, v164
  v_min3_f32 v177, v162, v163, v164
  v_max3_f32 v176, v176, v165, v166
  v_min3_f32 v177, v177, v165, v166
  v_max3_f32 v176, v176, v167, v168
  v_min3_f32 v177, v177, v167, v168
  v_max3_f32 v176, v176, v169, v170
  v_min3_f32 v177, v177, v169, v170
  v_mov_b32 v178, v176
  v_mov_b32 v179, v177
  s_nop 0
  v_permlane32_swap_b32 v176, v178
  v_permlane32_swap_b32 v177, v179
  v_max_f32 v176, v176, v178
  v_min_f32 v177, v177, v179
  v_mul_f32 v176, 0xbfb8aa3b, v176
  v_mul_f32 v177, 0x3fb8aa3b, v177
  v_mov_b32 v178, 0x3fb8aa3b
  v_mov_b32 v179, 0xbfb8aa3b
  v_fma_f32 v0, v162, v178, v176
  v_fma_f32 v180, v162, v179, v177
  v_fma_f32 v1, v163, v178, v176
  v_fma_f32 v181, v163, v179, v177
  v_fma_f32 v2, v164, v178, v176
  v_fma_f32 v182, v164, v179, v177
  v_fma_f32 v3, v165, v178, v176
  v_fma_f32 v183, v165, v179, v177
  v_fma_f32 v4, v166, v178, v176
  v_fma_f32 v184, v166, v179, v177
  v_fma_f32 v5, v167, v178, v176
  v_fma_f32 v185, v167, v179, v177
  v_fma_f32 v6, v168, v178, v176
  v_fma_f32 v186, v168, v179, v177
  v_fma_f32 v7, v169, v178, v176
  v_fma_f32 v187, v169, v179, v177
  v_fma_f32 v8, v170, v178, v176
  v_fma_f32 v188, v170, v179, v177
  v_exp_f32 v0, v0
  v_exp_f32 v180, v180
  v_exp_f32 v1, v1
  v_exp_f32 v181, v181
  v_exp_f32 v2, v2
  v_exp_f32 v182, v182
  v_exp_f32 v3, v3
  v_exp_f32 v183, v183
  v_exp_f32 v4, v4
  v_exp_f32 v184, v184
  v_exp_f32 v5, v5
  v_exp_f32 v185, v185
  v_exp_f32 v6, v6
  v_exp_f32 v186, v186
  v_exp_f32 v7, v7
  v_exp_f32 v187, v187
  v_exp_f32 v8, v8
  v_exp_f32 v188, v188
  v_add_f32 v176, v0, v1
  v_add_f32 v177, v180, v181
  v_add_f32 v176, v176, v2
  v_add_f32 v177, v177, v182
  v_add_f32 v176, v176, v3
  v_add_f32 v177, v177, v183
  v_add_f32 v176, v176, v4
  v_add_f32 v177, v177, v184
  v_add_f32 v176, v176, v5
  v_add_f32 v177, v177, v185
  v_add_f32 v176, v176, v6
  v_add_f32 v177, v177, v186
  v_add_f32 v176, v176, v7
  v_add_f32 v177, v177, v187
  v_add_f32 v176, v176, v8
  v_add_f32 v177, v177, v188
  v_mov_b32 v178, v176
  v_mov_b32 v179, v177
  s_nop 0
  v_permlane32_swap_b32 v176, v178
  v_permlane32_swap_b32 v177, v179
  v_add_f32 v176, v176, v178
  v_add_f32 v177, v177, v179
  v_rcp_f32 v176, v176
  v_rcp_f32 v177, v177
  v_mul_f32 v0, v0, v176
  v_mul_f32 v180, v180, v177
  v_mul_f32 v1, v1, v176
  v_mul_f32 v181, v181, v177
  v_mul_f32 v2, v2, v176
  v_mul_f32 v182, v182, v177
  v_mul_f32 v3, v3, v176
  v_mul_f32 v183, v183, v177
  v_mul_f32 v4, v4, v176
  v_mul_f32 v184, v184, v177
  v_mul_f32 v5, v5, v176
  v_mul_f32 v185, v185, v177
  v_mul_f32 v6, v6, v176
  v_mul_f32 v186, v186, v177
  v_mul_f32 v7, v7, v176
  v_mul_f32 v187, v187, v177
  v_mul_f32 v8, v8, v176
  v_mul_f32 v188, v188, v177
  v_cvt_pk_bf16_f32 v40, v0, v1
  v_cvt_pk_bf16_f32 v41, v2, v3
  v_cvt_pk_bf16_f32 v42, v4, v5
  v_cvt_pk_bf16_f32 v43, v6, v7
  v_cvt_pk_bf16_f32 v44, v8, v8
  v_cvt_pk_bf16_f32 v46, v180, v181
  v_cvt_pk_bf16_f32 v47, v182, v183
  v_cvt_pk_bf16_f32 v48, v184, v185
  v_cvt_pk_bf16_f32 v49, v186, v187
  v_cvt_pk_bf16_f32 v50, v188, v188
  s_add_u32 s41, s40, 0
  s_lshl_b32 s42, s41, 11
  s_add_u32 s42, s42, 2621440
  s_lshl_b32 s43, s41, 8
  s_add_u32 s43, s43, 6815744
  buffer_store_dwordx4 v[40:43], v56, s[16:19], s42 offen sc0 sc1
  buffer_store_dwordx4 v[46:49], v56, s[16:19], s42 offen offset:1024 sc0 sc1
  v_and_b32 v44, 0xffff, v44
  v_lshl_or_b32 v44, v50, 16, v44
  buffer_store_dword v44, v57, s[16:19], s43 offen sc0 sc1
  v_mfma_f32_32x32x16_bf16 v[0:15], v[240:243], v[122:125], 0
  v_mfma_f32_32x32x16_bf16 v[0:15], v[244:247], v[126:129], v[0:15]
  s_nop 11
  v_cvt_pk_bf16_f32 v171, v0, v1
  v_cvt_pk_bf16_f32 v172, v2, v3
  v_cvt_pk_bf16_f32 v173, v4, v5
  v_cvt_pk_bf16_f32 v174, v6, v7
  v_cvt_pk_bf16_f32 v175, v8, v8
  v_lshlrev_b32 v162, 16, v171
  v_and_b32 v163, 0xffff0000, v171
  v_lshlrev_b32 v164, 16, v172
  v_and_b32 v165, 0xffff0000, v172
  v_lshlrev_b32 v166, 16, v173
  v_and_b32 v167, 0xffff0000, v173
  v_lshlrev_b32 v168, 16, v174
  v_and_b32 v169, 0xffff0000, v174
  v_lshlrev_b32 v170, 16, v175
  v_max3_f32 v176, v162, v163, v164
  v_min3_f32 v177, v162, v163, v164
  v_max3_f32 v176, v176, v165, v166
  v_min3_f32 v177, v177, v165, v166
  v_max3_f32 v176, v176, v167, v168
  v_min3_f32 v177, v177, v167, v168
  v_max3_f32 v176, v176, v169, v170
  v_min3_f32 v177, v177, v169, v170
  v_mov_b32 v178, v176
  v_mov_b32 v179, v177
  s_nop 0
  v_permlane32_swap_b32 v176, v178
  v_permlane32_swap_b32 v177, v179
  v_max_f32 v176, v176, v178
  v_min_f32 v177, v177, v179
  v_mul_f32 v176, 0xbfb8aa3b, v176
  v_mul_f32 v177, 0x3fb8aa3b, v177
  v_mov_b32 v178, 0x3fb8aa3b
  v_mov_b32 v179, 0xbfb8aa3b
  v_fma_f32 v0, v162, v178, v176
  v_fma_f32 v180, v162, v179, v177
  v_fma_f32 v1, v163, v178, v176
  v_fma_f32 v181, v163, v179, v177
  v_fma_f32 v2, v164, v178, v176
  v_fma_f32 v182, v164, v179, v177
  v_fma_f32 v3, v165, v178, v176
  v_fma_f32 v183, v165, v179, v177
  v_fma_f32 v4, v166, v178, v176
  v_fma_f32 v184, v166, v179, v177
  v_fma_f32 v5, v167, v178, v176
  v_fma_f32 v185, v167, v179, v177
  v_fma_f32 v6, v168, v178, v176
  v_fma_f32 v186, v168, v179, v177
  v_fma_f32 v7, v169, v178, v176
  v_fma_f32 v187, v169, v179, v177
  v_fma_f32 v8, v170, v178, v176
  v_fma_f32 v188, v170, v179, v177
  v_exp_f32 v0, v0
  v_exp_f32 v180, v180
  v_exp_f32 v1, v1
  v_exp_f32 v181, v181
  v_exp_f32 v2, v2
  v_exp_f32 v182, v182
  v_exp_f32 v3, v3
  v_exp_f32 v183, v183
  v_exp_f32 v4, v4
  v_exp_f32 v184, v184
  v_exp_f32 v5, v5
  v_exp_f32 v185, v185
  v_exp_f32 v6, v6
  v_exp_f32 v186, v186
  v_exp_f32 v7, v7
  v_exp_f32 v187, v187
  v_exp_f32 v8, v8
  v_exp_f32 v188, v188
  v_add_f32 v176, v0, v1
  v_add_f32 v177, v180, v181
  v_add_f32 v176, v176, v2
  v_add_f32 v177, v177, v182
  v_add_f32 v176, v176, v3
  v_add_f32 v177, v177, v183
  v_add_f32 v176, v176, v4
  v_add_f32 v177, v177, v184
  v_add_f32 v176, v176, v5
  v_add_f32 v177, v177, v185
  v_add_f32 v176, v176, v6
  v_add_f32 v177, v177, v186
  v_add_f32 v176, v176, v7
  v_add_f32 v177, v177, v187
  v_add_f32 v176, v176, v8
  v_add_f32 v177, v177, v188
  v_mov_b32 v178, v176
  v_mov_b32 v179, v177
  s_nop 0
  v_permlane32_swap_b32 v176, v178
  v_permlane32_swap_b32 v177, v179
  v_add_f32 v176, v176, v178
  v_add_f32 v177, v177, v179
  v_rcp_f32 v176, v176
  v_rcp_f32 v177, v177
  v_mul_f32 v0, v0, v176
  v_mul_f32 v180, v180, v177
  v_mul_f32 v1, v1, v176
  v_mul_f32 v181, v181, v177
  v_mul_f32 v2, v2, v176
  v_mul_f32 v182, v182, v177
  v_mul_f32 v3, v3, v176
  v_mul_f32 v183, v183, v177
  v_mul_f32 v4, v4, v176
  v_mul_f32 v184, v184, v177
  v_mul_f32 v5, v5, v176
  v_mul_f32 v185, v185, v177
  v_mul_f32 v6, v6, v176
  v_mul_f32 v186, v186, v177
  v_mul_f32 v7, v7, v176
  v_mul_f32 v187, v187, v177
  v_mul_f32 v8, v8, v176
  v_mul_f32 v188, v188, v177
  v_cvt_pk_bf16_f32 v16, v0, v1
  v_cvt_pk_bf16_f32 v17, v2, v3
  v_cvt_pk_bf16_f32 v18, v4, v5
  v_cvt_pk_bf16_f32 v19, v6, v7
  v_cvt_pk_bf16_f32 v20, v8, v8
  v_cvt_pk_bf16_f32 v22, v180, v181
  v_cvt_pk_bf16_f32 v23, v182, v183
  v_cvt_pk_bf16_f32 v24, v184, v185
  v_cvt_pk_bf16_f32 v25, v186, v187
  v_cvt_pk_bf16_f32 v26, v188, v188
  v_mfma_f32_32x32x16_bf16 v[0:15], v[248:251], v[116:119], 0
  v_mov_b32 v52, v120
  v_mov_b32 v53, v121
  v_mov_b32 v54, 0
  v_mov_b32 v55, 0
  s_nop 1
  v_mfma_f32_32x32x16_bf16 v[0:15], v[252:255], v[52:55], v[0:15]
  s_nop 11
  v_cvt_pk_bf16_f32 v171, v0, v1
  v_cvt_pk_bf16_f32 v172, v2, v3
  v_cvt_pk_bf16_f32 v173, v4, v5
  v_cvt_pk_bf16_f32 v174, v6, v7
  v_cvt_pk_bf16_f32 v175, v8, v8
  v_lshlrev_b32 v162, 16, v171
  v_and_b32 v163, 0xffff0000, v171
  v_lshlrev_b32 v164, 16, v172
  v_and_b32 v165, 0xffff0000, v172
  v_lshlrev_b32 v166, 16, v173
  v_and_b32 v167, 0xffff0000, v173
  v_lshlrev_b32 v168, 16, v174
  v_and_b32 v169, 0xffff0000, v174
  v_lshlrev_b32 v170, 16, v175
  v_max3_f32 v176, v162, v163, v164
  v_min3_f32 v177, v162, v163, v164
  v_max3_f32 v176, v176, v165, v166
  v_min3_f32 v177, v177, v165, v166
  v_max3_f32 v176, v176, v167, v168
  v_min3_f32 v177, v177, v167, v168
  v_max3_f32 v176, v176, v169, v170
  v_min3_f32 v177, v177, v169, v170
  v_mov_b32 v178, v176
  v_mov_b32 v179, v177
  s_nop 0
  v_permlane32_swap_b32 v176, v178
  v_permlane32_swap_b32 v177, v179
  v_max_f32 v176, v176, v178
  v_min_f32 v177, v177, v179
  v_mul_f32 v176, 0xbfb8aa3b, v176
  v_mul_f32 v177, 0x3fb8aa3b, v177
  v_mov_b32 v178, 0x3fb8aa3b
  v_mov_b32 v179, 0xbfb8aa3b
  v_fma_f32 v0, v162, v178, v176
  v_fma_f32 v180, v162, v179, v177
  v_fma_f32 v1, v163, v178, v176
  v_fma_f32 v181, v163, v179, v177
  v_fma_f32 v2, v164, v178, v176
  v_fma_f32 v182, v164, v179, v177
  v_fma_f32 v3, v165, v178, v176
  v_fma_f32 v183, v165, v179, v177
  v_fma_f32 v4, v166, v178, v176
  v_fma_f32 v184, v166, v179, v177
  v_fma_f32 v5, v167, v178, v176
  v_fma_f32 v185, v167, v179, v177
  v_fma_f32 v6, v168, v178, v176
  v_fma_f32 v186, v168, v179, v177
  v_fma_f32 v7, v169, v178, v176
  v_fma_f32 v187, v169, v179, v177
  v_fma_f32 v8, v170, v178, v176
  v_fma_f32 v188, v170, v179, v177
  v_exp_f32 v0, v0
  v_exp_f32 v180, v180
  v_exp_f32 v1, v1
  v_exp_f32 v181, v181
  v_exp_f32 v2, v2
  v_exp_f32 v182, v182
  v_exp_f32 v3, v3
  v_exp_f32 v183, v183
  v_exp_f32 v4, v4
  v_exp_f32 v184, v184
  v_exp_f32 v5, v5
  v_exp_f32 v185, v185
  v_exp_f32 v6, v6
  v_exp_f32 v186, v186
  v_exp_f32 v7, v7
  v_exp_f32 v187, v187
  v_exp_f32 v8, v8
  v_exp_f32 v188, v188
  v_add_f32 v176, v0, v1
  v_add_f32 v177, v180, v181
  v_add_f32 v176, v176, v2
  v_add_f32 v177, v177, v182
  v_add_f32 v176, v176, v3
  v_add_f32 v177, v177, v183
  v_add_f32 v176, v176, v4
  v_add_f32 v177, v177, v184
  v_add_f32 v176, v176, v5
  v_add_f32 v177, v177, v185
  v_add_f32 v176, v176, v6
  v_add_f32 v177, v177, v186
  v_add_f32 v176, v176, v7
  v_add_f32 v177, v177, v187
  v_add_f32 v176, v176, v8
  v_add_f32 v177, v177, v188
  v_mov_b32 v178, v176
  v_mov_b32 v179, v177
  s_nop 0
  v_permlane32_swap_b32 v176, v178
  v_permlane32_swap_b32 v177, v179
  v_add_f32 v176, v176, v178
  v_add_f32 v177, v177, v179
  v_rcp_f32 v176, v176
  v_rcp_f32 v177, v177
  v_mul_f32 v0, v0, v176
  v_mul_f32 v180, v180, v177
  v_mul_f32 v1, v1, v176
  v_mul_f32 v181, v181, v177
  v_mul_f32 v2, v2, v176
  v_mul_f32 v182, v182, v177
  v_mul_f32 v3, v3, v176
  v_mul_f32 v183, v183, v177
  v_mul_f32 v4, v4, v176
  v_mul_f32 v184, v184, v177
  v_mul_f32 v5, v5, v176
  v_mul_f32 v185, v185, v177
  v_mul_f32 v6, v6, v176
  v_mul_f32 v186, v186, v177
  v_mul_f32 v7, v7, v176
  v_mul_f32 v187, v187, v177
  v_mul_f32 v8, v8, v176
  v_mul_f32 v188, v188, v177
  v_cvt_pk_bf16_f32 v40, v0, v1
  v_cvt_pk_bf16_f32 v41, v2, v3
  v_cvt_pk_bf16_f32 v42, v4, v5
  v_cvt_pk_bf16_f32 v43, v6, v7
  v_cvt_pk_bf16_f32 v44, v8, v8
  v_cvt_pk_bf16_f32 v46, v180, v181
  v_cvt_pk_bf16_f32 v47, v182, v183
  v_cvt_pk_bf16_f32 v48, v184, v185
  v_cvt_pk_bf16_f32 v49, v186, v187
  v_cvt_pk_bf16_f32 v50, v188, v188
  s_add_u32 s41, s40, 1
  s_lshl_b32 s42, s41, 11
  s_add_u32 s42, s42, 2621440
  s_lshl_b32 s43, s41, 8
  s_add_u32 s43, s43, 6815744
  buffer_store_dwordx4 v[40:43], v56, s[16:19], s42 offen sc0 sc1
  buffer_store_dwordx4 v[46:49], v56, s[16:19], s42 offen offset:1024 sc0 sc1
  v_and_b32 v44, 0xffff, v44
  v_lshl_or_b32 v44, v50, 16, v44
  buffer_store_dword v44, v57, s[16:19], s43 offen sc0 sc1
  v_mfma_f32_32x32x16_bf16 v[0:15], v[248:251], v[126:129], 0
  v_mov_b32 v52, v130
  v_mov_b32 v53, v131
  v_mov_b32 v54, 0
  v_mov_b32 v55, 0
  s_nop 1
  v_mfma_f32_32x32x16_bf16 v[0:15], v[252:255], v[52:55], v[0:15]
  s_nop 11
  v_cvt_pk_bf16_f32 v171, v0, v1
  v_cvt_pk_bf16_f32 v172, v2, v3
  v_cvt_pk_bf16_f32 v173, v4, v5
  v_cvt_pk_bf16_f32 v174, v6, v7
  v_cvt_pk_bf16_f32 v175, v8, v8
  v_lshlrev_b32 v162, 16, v171
  v_and_b32 v163, 0xffff0000, v171
  v_lshlrev_b32 v164, 16, v172
  v_and_b32 v165, 0xffff0000, v172
  v_lshlrev_b32 v166, 16, v173
  v_and_b32 v167, 0xffff0000, v173
  v_lshlrev_b32 v168, 16, v174
  v_and_b32 v169, 0xffff0000, v174
  v_lshlrev_b32 v170, 16, v175
  v_max3_f32 v176, v162, v163, v164
  v_min3_f32 v177, v162, v163, v164
  v_max3_f32 v176, v176, v165, v166
  v_min3_f32 v177, v177, v165, v166
  v_max3_f32 v176, v176, v167, v168
  v_min3_f32 v177, v177, v167, v168
  v_max3_f32 v176, v176, v169, v170
  v_min3_f32 v177, v177, v169, v170
  v_mov_b32 v178, v176
  v_mov_b32 v179, v177
  s_nop 0
  v_permlane32_swap_b32 v176, v178
  v_permlane32_swap_b32 v177, v179
  v_max_f32 v176, v176, v178
  v_min_f32 v177, v177, v179
  v_mul_f32 v176, 0xbfb8aa3b, v176
  v_mul_f32 v177, 0x3fb8aa3b, v177
  v_mov_b32 v178, 0x3fb8aa3b
  v_mov_b32 v179, 0xbfb8aa3b
  v_fma_f32 v0, v162, v178, v176
  v_fma_f32 v180, v162, v179, v177
  v_fma_f32 v1, v163, v178, v176
  v_fma_f32 v181, v163, v179, v177
  v_fma_f32 v2, v164, v178, v176
  v_fma_f32 v182, v164, v179, v177
  v_fma_f32 v3, v165, v178, v176
  v_fma_f32 v183, v165, v179, v177
  v_fma_f32 v4, v166, v178, v176
  v_fma_f32 v184, v166, v179, v177
  v_fma_f32 v5, v167, v178, v176
  v_fma_f32 v185, v167, v179, v177
  v_fma_f32 v6, v168, v178, v176
  v_fma_f32 v186, v168, v179, v177
  v_fma_f32 v7, v169, v178, v176
  v_fma_f32 v187, v169, v179, v177
  v_fma_f32 v8, v170, v178, v176
  v_fma_f32 v188, v170, v179, v177
  v_exp_f32 v0, v0
  v_exp_f32 v180, v180
  v_exp_f32 v1, v1
  v_exp_f32 v181, v181
  v_exp_f32 v2, v2
  v_exp_f32 v182, v182
  v_exp_f32 v3, v3
  v_exp_f32 v183, v183
  v_exp_f32 v4, v4
  v_exp_f32 v184, v184
  v_exp_f32 v5, v5
  v_exp_f32 v185, v185
  v_exp_f32 v6, v6
  v_exp_f32 v186, v186
  v_exp_f32 v7, v7
  v_exp_f32 v187, v187
  v_exp_f32 v8, v8
  v_exp_f32 v188, v188
  v_add_f32 v176, v0, v1
  v_add_f32 v177, v180, v181
  v_add_f32 v176, v176, v2
  v_add_f32 v177, v177, v182
  v_add_f32 v176, v176, v3
  v_add_f32 v177, v177, v183
  v_add_f32 v176, v176, v4
  v_add_f32 v177, v177, v184
  v_add_f32 v176, v176, v5
  v_add_f32 v177, v177, v185
  v_add_f32 v176, v176, v6
  v_add_f32 v177, v177, v186
  v_add_f32 v176, v176, v7
  v_add_f32 v177, v177, v187
  v_add_f32 v176, v176, v8
  v_add_f32 v177, v177, v188
  v_mov_b32 v178, v176
  v_mov_b32 v179, v177
  s_nop 0
  v_permlane32_swap_b32 v176, v178
  v_permlane32_swap_b32 v177, v179
  v_add_f32 v176, v176, v178
  v_add_f32 v177, v177, v179
  v_rcp_f32 v176, v176
  v_rcp_f32 v177, v177
  v_mul_f32 v0, v0, v176
  v_mul_f32 v180, v180, v177
  v_mul_f32 v1, v1, v176
  v_mul_f32 v181, v181, v177
  v_mul_f32 v2, v2, v176
  v_mul_f32 v182, v182, v177
  v_mul_f32 v3, v3, v176
  v_mul_f32 v183, v183, v177
  v_mul_f32 v4, v4, v176
  v_mul_f32 v184, v184, v177
  v_mul_f32 v5, v5, v176
  v_mul_f32 v185, v185, v177
  v_mul_f32 v6, v6, v176
  v_mul_f32 v186, v186, v177
  v_mul_f32 v7, v7, v176
  v_mul_f32 v187, v187, v177
  v_mul_f32 v8, v8, v176
  v_mul_f32 v188, v188, v177
  v_cvt_pk_bf16_f32 v28, v0, v1
  v_cvt_pk_bf16_f32 v29, v2, v3
  v_cvt_pk_bf16_f32 v30, v4, v5
  v_cvt_pk_bf16_f32 v31, v6, v7
  v_cvt_pk_bf16_f32 v32, v8, v8
  v_cvt_pk_bf16_f32 v34, v180, v181
  v_cvt_pk_bf16_f32 v35, v182, v183
  v_cvt_pk_bf16_f32 v36, v184, v185
  v_cvt_pk_bf16_f32 v37, v186, v187
  v_cvt_pk_bf16_f32 v38, v188, v188
  s_barrier
  v_and_b32 v162, 31, v192
  v_lshrrev_b32 v163, 5, v192
  s_lshl_b32 s40, s25, 5
  v_add_u32 v162, s40, v162
  v_mul_u32_u24 v162, 584, v162
  v_lshl_add_u32 v190, v163, 3, v162
  v_mul_u32_u24 v163, 12, v163
  v_add_u32 v191, v163, v162
  ds_write_b64 v190, v[16:17] offset:0
  ds_write_b64 v190, v[18:19] offset:16
  ds_write_b16 v190, v20 offset:32
  ds_write_b64 v190, v[22:23] offset:48
  ds_write_b64 v190, v[24:25] offset:64
  ds_write_b16 v190, v26 offset:80
  ds_write_b64 v190, v[28:29] offset:96
  ds_write_b64 v190, v[30:31] offset:112
  ds_write_b16 v190, v32 offset:128
  ds_write_b64 v190, v[34:35] offset:144
  ds_write_b64 v190, v[36:37] offset:160
  ds_write_b16 v190, v38 offset:176
  ds_write_b32 v190, v132 offset:384
  ds_write_b32 v190, v133 offset:388
  ds_write_b32 v190, v134 offset:400
  s_waitcnt lgkmcnt(13)
  ds_write_b32 v190, v135 offset:404
  ds_write_b32 v191, v136 offset:416
  s_waitcnt lgkmcnt(13)
  ds_write_b32 v190, v137 offset:424
  ds_write_b32 v190, v138 offset:436
  s_waitcnt lgkmcnt(13)
  ds_write_b32 v190, v139 offset:440
  ds_write_b32 v191, v140 offset:452
  s_waitcnt lgkmcnt(13)
  ds_write_b32 v191, v141 offset:456
  s_waitcnt lgkmcnt(0)
  s_barrier
  s_mul_i32 s42, s24, 24
  s_lshr_b32 s43, s24, 1
  s_mul_i32 s43, s43, 20
  s_add_u32 s43, s43, 192
  s_lshl_b32 s46, s30, 3
  s_add_u32 s46, s46, s24
  s_add_u32 s46, s46, 32
  v_lshrrev_b32 v162, 5, v192
  v_lshrrev_b32 v163, 4, v192
  v_and_b32 v163, 1, v163
  v_and_b32 v164, 15, v192
  v_lshrrev_b32 v165, 2, v164
  v_and_b32 v166, 3, v164
  v_lshl_add_u32 v167, v162, 3, v165
  v_mul_u32_u24 v167, 584, v167
  v_lshlrev_b32 v168, 5, v163
  v_lshl_add_u32 v168, v166, 3, v168
  v_add_u32 v167, v167, v168
  s_lshl_b32 s42, s42, 1
  s_lshl_b32 s43, s43, 1
  v_add_u32 v168, s42, v167
  v_add_u32 v169, s43, v167
  v_add_u32 v170, 37376, v168
  v_add_u32 v171, 37376, v169
  v_mov_b32 v172, 0x3f803f80
  s_mov_b32 s44, 0x00440000
  s_mov_b32 s45, 0x00440000
  ds_read_b64_tr_b16 v[0:1], v168 offset:0
  ds_read_b64_tr_b16 v[32:33], v169 offset:0
  ds_read_b64_tr_b16 v[2:3], v168 offset:2336
  ds_read_b64_tr_b16 v[34:35], v169 offset:2336
  ds_read_b64_tr_b16 v[4:5], v168 offset:9344
  ds_read_b64_tr_b16 v[36:37], v169 offset:9344
  ds_read_b64_tr_b16 v[6:7], v168 offset:11680
  ds_read_b64_tr_b16 v[38:39], v169 offset:11680
  ds_read_b64_tr_b16 v[8:9], v168 offset:18688
  ds_read_b64_tr_b16 v[40:41], v169 offset:18688
  ds_read_b64_tr_b16 v[10:11], v168 offset:21024
  ds_read_b64_tr_b16 v[42:43], v169 offset:21024
  ds_read_b64_tr_b16 v[12:13], v168 offset:28032
  ds_read_b64_tr_b16 v[44:45], v169 offset:28032
  ds_read_b64_tr_b16 v[14:15], v168 offset:30368
  s_waitcnt lgkmcnt(13)
  ds_read_b64_tr_b16 v[46:47], v169 offset:30368
  ds_read_b64_tr_b16 v[16:17], v170 offset:0
  s_waitcnt lgkmcnt(13)
  ds_read_b64_tr_b16 v[48:49], v171 offset:0
  ds_read_b64_tr_b16 v[18:19], v170 offset:2336
  s_waitcnt lgkmcnt(13)
  ds_read_b64_tr_b16 v[50:51], v171 offset:2336
  ds_read_b64_tr_b16 v[20:21], v170 offset:9344
  s_waitcnt lgkmcnt(13)
  ds_read_b64_tr_b16 v[52:53], v171 offset:9344
  ds_read_b64_tr_b16 v[22:23], v170 offset:11680
  s_waitcnt lgkmcnt(13)
  ds_read_b64_tr_b16 v[54:55], v171 offset:11680
  ds_read_b64_tr_b16 v[24:25], v170 offset:18688
  s_waitcnt lgkmcnt(13)
  ds_read_b64_tr_b16 v[56:57], v171 offset:18688
  ds_read_b64_tr_b16 v[26:27], v170 offset:21024
  s_waitcnt lgkmcnt(13)
  ds_read_b64_tr_b16 v[58:59], v171 offset:21024
  ds_read_b64_tr_b16 v[28:29], v170 offset:28032
  s_waitcnt lgkmcnt(13)
  ds_read_b64_tr_b16 v[60:61], v171 offset:28032
  ds_read_b64_tr_b16 v[30:31], v170 offset:30368
  s_waitcnt lgkmcnt(13)
  ds_read_b64_tr_b16 v[62:63], v171 offset:30368
  v_cndmask_b32 v32, v32, v172, s[44:45]
  v_cndmask_b32 v33, v33, v172, s[44:45]
  v_cndmask_b32 v34, v34, v172, s[44:45]
  v_cndmask_b32 v35, v35, v172, s[44:45]
  s_nop 1
  v_mfma_f32_32x32x16_bf16 v[64:79], v[0:3], v[32:35], 0
  v_cndmask_b32 v36, v36, v172, s[44:45]
  v_cndmask_b32 v37, v37, v172, s[44:45]
  v_cndmask_b32 v38, v38, v172, s[44:45]
  v_cndmask_b32 v39, v39, v172, s[44:45]
  s_nop 1
  v_mfma_f32_32x32x16_bf16 v[64:79], v[4:7], v[36:39], v[64:79]
  v_cndmask_b32 v40, v40, v172, s[44:45]
  v_cndmask_b32 v41, v41, v172, s[44:45]
  v_cndmask_b32 v42, v42, v172, s[44:45]
  v_cndmask_b32 v43, v43, v172, s[44:45]
  s_nop 1
  v_mfma_f32_32x32x16_bf16 v[64:79], v[8:11], v[40:43], v[64:79]
  v_cndmask_b32 v44, v44, v172, s[44:45]
  v_cndmask_b32 v45, v45, v172, s[44:45]
  v_cndmask_b32 v46, v46, v172, s[44:45]
  v_cndmask_b32 v47, v47, v172, s[44:45]
  s_nop 1
  v_mfma_f32_32x32x16_bf16 v[64:79], v[12:15], v[44:47], v[64:79]
  v_cndmask_b32 v48, v48, v172, s[44:45]
  v_cndmask_b32 v49, v49, v172, s[44:45]
  s_waitcnt lgkmcnt(12)
  v_cndmask_b32 v50, v50, v172, s[44:45]
  v_cndmask_b32 v51, v51, v172, s[44:45]
  s_nop 1
  v_mfma_f32_32x32x16_bf16 v[64:79], v[16:19], v[48:51], v[64:79]
  s_waitcnt lgkmcnt(10)
  v_cndmask_b32 v52, v52, v172, s[44:45]
  v_cndmask_b32 v53, v53, v172, s[44:45]
  s_waitcnt lgkmcnt(8)
  v_cndmask_b32 v54, v54, v172, s[44:45]
  v_cndmask_b32 v55, v55, v172, s[44:45]
  s_nop 1
  v_mfma_f32_32x32x16_bf16 v[64:79], v[20:23], v[52:55], v[64:79]
  s_waitcnt lgkmcnt(6)
  v_cndmask_b32 v56, v56, v172, s[44:45]
  v_cndmask_b32 v57, v57, v172, s[44:45]
  s_waitcnt lgkmcnt(4)
  v_cndmask_b32 v58, v58, v172, s[44:45]
  v_cndmask_b32 v59, v59, v172, s[44:45]
  s_nop 1
  v_mfma_f32_32x32x16_bf16 v[64:79], v[24:27], v[56:59], v[64:79]
  s_waitcnt lgkmcnt(2)
  v_cndmask_b32 v60, v60, v172, s[44:45]
  v_cndmask_b32 v61, v61, v172, s[44:45]
  s_waitcnt lgkmcnt(0)
  v_cndmask_b32 v62, v62, v172, s[44:45]
  v_cndmask_b32 v63, v63, v172, s[44:45]
  s_nop 1
  v_mfma_f32_32x32x16_bf16 v[64:79], v[28:31], v[60:63], v[64:79]
  s_mul_i32 s40, s27, 96
  s_add_u32 s40, s40, s46
  s_mul_i32 s40, s40, 3072
  s_add_u32 s40, s40, 7340032
  v_lshlrev_b32 v162, 4, v192
  s_nop 6
  buffer_store_dwordx4 v[64:67], v162, s[16:19], s40 offen offset:0 sc0 sc1
  buffer_store_dwordx4 v[68:71], v162, s[16:19], s40 offen offset:1024 sc0 sc1
  buffer_store_dwordx4 v[72:75], v162, s[16:19], s40 offen offset:2048 sc0 sc1
  s_endpgm
k1_role1:
  s_waitcnt vmcnt(0)
  s_nop 15
  s_nop 7
  v_and_b32 v193, 31, v192
  v_lshrrev_b32 v194, 5, v192
  v_bfe_u32 v195, v192, 1, 3
  s_lshl_b32 s31, s25, 12
  s_add_u32 s31, s31, 28672
  v_lshlrev_b32 v196, 7, v193
  v_add_u32 v196, s31, v196
  v_add_u32 v197, 4, v194
  v_xor_b32 v197, v197, v195
  v_lshl_add_u32 v179, v197, 4, v196
  v_add_u32 v180, 45056, v179
  v_add_u32 v181, 90112, v179
  v_add_u32 v197, 6, v194
  v_xor_b32 v197, v197, v195
  v_lshl_add_u32 v182, v197, 4, v196
  v_add_u32 v183, 45056, v182
  v_add_u32 v184, 90112, v182
  v_lshrrev_b32 v193, 3, v192
  v_mul_u32_u24 v193, 1152, v193
  v_and_b32 v194, 7, v192
  v_lshrrev_b32 v195, 4, v192
  v_xor_b32 v196, v194, v195
  v_lshl_add_u32 v185, v196, 4, v193
  v_xor_b32 v196, 4, v196
  v_lshl_add_u32 v186, v196, 4, v193
  s_lshl_b32 s39, s27, 7
  s_lshl_b32 s40, s25, 5
  s_add_u32 s39, s39, s40
  s_mul_i32 s39, s39, 1152
  s_add_u32 s40, s39, 0
  s_lshl_b32 s41, s25, 12
  s_add_u32 m0, s41, 28672
  s_nop 0
  buffer_load_dwordx4 v185, s[12:15], s40 offen lds
  s_add_u32 s40, s39, 9216
  s_lshl_b32 s41, s25, 12
  s_add_u32 m0, s41, 29696
  s_nop 0
  buffer_load_dwordx4 v186, s[12:15], s40 offen lds
  s_add_u32 s40, s39, 18432
  s_lshl_b32 s41, s25, 12
  s_add_u32 m0, s41, 30720
  s_nop 0
  buffer_load_dwordx4 v185, s[12:15], s40 offen lds
  s_add_u32 s40, s39, 27648
  s_lshl_b32 s41, s25, 12
  s_add_u32 m0, s41, 31744
  s_nop 0
  buffer_load_dwordx4 v186, s[12:15], s40 offen lds
  s_add_u32 s40, s39, 128
  s_lshl_b32 s41, s25, 12
  s_add_u32 m0, s41, 73728
  s_nop 0
  buffer_load_dwordx4 v185, s[12:15], s40 offen lds
  s_add_u32 s40, s39, 9344
  s_lshl_b32 s41, s25, 12
  s_add_u32 m0, s41, 74752
  s_nop 0
  buffer_load_dwordx4 v186, s[12:15], s40 offen lds
  s_add_u32 s40, s39, 18560
  s_lshl_b32 s41, s25, 12
  s_add_u32 m0, s41, 75776
  s_nop 0
  buffer_load_dwordx4 v185, s[12:15], s40 offen lds
  s_add_u32 s40, s39, 27776
  s_lshl_b32 s41, s25, 12
  s_add_u32 m0, s41, 76800
  s_nop 0
  buffer_load_dwordx4 v186, s[12:15], s40 offen lds
  s_add_u32 s40, s39, 256
  s_lshl_b32 s41, s25, 12
  s_add_u32 m0, s41, 118784
  s_nop 0
  buffer_load_dwordx4 v185, s[12:15], s40 offen lds
  s_add_u32 s40, s39, 9472
  s_lshl_b32 s41, s25, 12
  s_add_u32 m0, s41, 119808
  s_nop 0
  buffer_load_dwordx4 v186, s[12:15], s40 offen lds
  s_add_u32 s40, s39, 18688
  s_lshl_b32 s41, s25, 12
  s_add_u32 m0, s41, 120832
  s_nop 0
  buffer_load_dwordx4 v185, s[12:15], s40 offen lds
  s_add_u32 s40, s39, 27904
  s_lshl_b32 s41, s25, 12
  s_add_u32 m0, s41, 121856
  s_nop 0
  buffer_load_dwordx4 v186, s[12:15], s40 offen lds
  s_load_dwordx2 s[48:49], s[0:1], 40
  v_and_b32 v193, 31, v192
  v_lshrrev_b32 v194, 5, v192
  v_mov_b32 v195, 0x7fff0000
  v_cmp_eq_u32 vcc, 20, v193
  s_nop 1
  v_cndmask_b32 v196, v195, 17, vcc
  v_cmp_ge_u32 vcc, 16, v193
  s_nop 1
  v_cndmask_b32 v196, v196, v193, vcc
  v_cmp_ge_u32 vcc, 17, v196
  v_lshlrev_b32 v197, 1, v196
  s_nop 0
  v_cndmask_b32 v196, v196, v197, vcc
  v_mul_u32_u24 v197, 144, v194
  v_add_u32 v197, v197, v196
  v_cmp_eq_u32 vcc, 1, v194
  s_nop 1
  v_cndmask_b32 v198, v195, v196, vcc
  v_cndmask_b32 v199, v196, v195, vcc
  s_waitcnt lgkmcnt(0)
  s_mov_b32 s20, s48
  s_and_b32 s21, s49, 0xffff
  s_mov_b32 s22, 0x5100
  s_mov_b32 s23, 0x20000
  s_lshl_b32 s47, s30, 2
  s_add_u32 s48, s47, 2
  s_mul_i32 s48, s48, 648
  buffer_load_ushort v208, v198, s[20:23], s48 offen offset:0
  buffer_load_ushort v209, v198, s[20:23], s48 offen offset:36
  buffer_load_ushort v210, v198, s[20:23], s48 offen offset:72
  buffer_load_ushort v211, v198, s[20:23], s48 offen offset:108
  buffer_load_ushort v212, v197, s[20:23], s48 offen offset:144
  buffer_load_ushort v213, v197, s[20:23], s48 offen offset:180
  buffer_load_ushort v214, v197, s[20:23], s48 offen offset:216
  buffer_load_ushort v215, v197, s[20:23], s48 offen offset:252
  buffer_load_ushort v216, v197, s[20:23], s48 offen offset:432
  buffer_load_ushort v217, v197, s[20:23], s48 offen offset:468
  buffer_load_ushort v218, v199, s[20:23], s48 offen offset:504
  buffer_load_ushort v219, v199, s[20:23], s48 offen offset:540
  v_mov_b32 v220, 0
  v_mov_b32 v221, 0
  v_mov_b32 v222, 0
  v_mov_b32 v223, 0
  s_add_u32 s48, s47, 3
  s_mul_i32 s48, s48, 648
  v_mov_b32 v224, 0
  v_mov_b32 v225, 0
  buffer_load_ushort v226, v198, s[20:23], s48 offen offset:0
  buffer_load_ushort v227, v198, s[20:23], s48 offen offset:36
  buffer_load_ushort v228, v197, s[20:23], s48 offen offset:72
  buffer_load_ushort v229, v197, s[20:23], s48 offen offset:108
  buffer_load_ushort v230, v197, s[20:23], s48 offen offset:144
  buffer_load_ushort v231, v197, s[20:23], s48 offen offset:180
  buffer_load_ushort v232, v197, s[20:23], s48 offen offset:360
  buffer_load_ushort v233, v197, s[20:23], s48 offen offset:396
  buffer_load_ushort v234, v197, s[20:23], s48 offen offset:432
  buffer_load_ushort v235, v197, s[20:23], s48 offen offset:468
  v_mov_b32 v236, 0
  v_mov_b32 v237, 0
  v_mov_b32 v238, 0
  v_mov_b32 v239, 0
  s_waitcnt vmcnt(30)
  s_barrier
  ds_read_b128 v[168:171], v179
  ds_read_b64_tr_b16 v[112:113], v176 offset:14336
  ds_read_b64_tr_b16 v[114:115], v176 offset:16128
  ds_read_b64_tr_b16 v[116:117], v176 offset:14400
  ds_read_b64_tr_b16 v[118:119], v176 offset:16192
  ds_read_b64_tr_b16 v[120:121], v176 offset:14464
  ds_read_b64_tr_b16 v[122:123], v176 offset:16256
  ds_read_b64_tr_b16 v[124:125], v176 offset:14528
  ds_read_b64_tr_b16 v[126:127], v176 offset:16320
  ds_read_b64_tr_b16 v[128:129], v176 offset:14592
  ds_read_b64_tr_b16 v[130:131], v176 offset:16384
  ds_read_b64_tr_b16 v[132:133], v176 offset:14656
  ds_read_b64_tr_b16 v[134:135], v176 offset:16448
  ds_read_b64_tr_b16 v[136:137], v176 offset:14720
  ds_read_b64_tr_b16 v[138:139], v176 offset:16512
  s_waitcnt lgkmcnt(12)
  v_mfma_f32_32x32x16_bf16 v[0:15], v[112:115], v[168:171], 0
  ds_read_b128 v[172:175], v182
  ds_read_b64_tr_b16 v[140:141], v176 offset:21504
  ds_read_b64_tr_b16 v[142:143], v176 offset:23296
  s_waitcnt lgkmcnt(13)
  ds_read_b64_tr_b16 v[144:145], v176 offset:21568
  ds_read_b64_tr_b16 v[146:147], v176 offset:23360
  v_mfma_f32_32x32x16_bf16 v[16:31], v[116:119], v[168:171], 0
  s_waitcnt lgkmcnt(13)
  ds_read_b64_tr_b16 v[148:149], v176 offset:21632
  ds_read_b64_tr_b16 v[150:151], v176 offset:23424
  s_waitcnt lgkmcnt(13)
  ds_read_b64_tr_b16 v[152:153], v176 offset:21696
  ds_read_b64_tr_b16 v[154:155], v176 offset:23488
  v_mfma_f32_32x32x16_bf16 v[32:47], v[120:123], v[168:171], 0
  s_waitcnt lgkmcnt(13)
  ds_read_b64_tr_b16 v[156:157], v176 offset:21760
  ds_read_b64_tr_b16 v[158:159], v176 offset:23552
  s_waitcnt lgkmcnt(13)
  ds_read_b64_tr_b16 v[160:161], v176 offset:21824
  ds_read_b64_tr_b16 v[162:163], v176 offset:23616
  v_mfma_f32_32x32x16_bf16 v[48:63], v[124:127], v[168:171], 0
  s_waitcnt lgkmcnt(13)
  ds_read_b64_tr_b16 v[164:165], v176 offset:21888
  ds_read_b64_tr_b16 v[166:167], v176 offset:23680
  v_mfma_f32_32x32x16_bf16 v[64:79], v[128:131], v[168:171], 0
  v_mfma_f32_32x32x16_bf16 v[80:95], v[132:135], v[168:171], 0
  v_mfma_f32_32x32x16_bf16 v[96:111], v[136:139], v[168:171], 0
  s_waitcnt lgkmcnt(0)
  s_waitcnt vmcnt(26)
  s_barrier
  s_add_u32 s40, s39, 384
  s_lshl_b32 s41, s25, 12
  s_add_u32 m0, s41, 28672
  s_nop 0
  buffer_load_dwordx4 v185, s[12:15], s40 offen lds
  s_add_u32 s40, s39, 9600
  s_lshl_b32 s41, s25, 12
  s_add_u32 m0, s41, 29696
  s_nop 0
  buffer_load_dwordx4 v186, s[12:15], s40 offen lds
  s_add_u32 s40, s39, 18816
  s_lshl_b32 s41, s25, 12
  s_add_u32 m0, s41, 30720
  s_nop 0
  buffer_load_dwordx4 v185, s[12:15], s40 offen lds
  s_add_u32 s40, s39, 28032
  s_lshl_b32 s41, s25, 12
  s_add_u32 m0, s41, 31744
  s_nop 0
  buffer_load_dwordx4 v186, s[12:15], s40 offen lds
  v_mfma_f32_32x32x16_bf16 v[0:15], v[140:143], v[172:175], v[0:15]
  ds_read_b128 v[168:171], v180
  ds_read_b64_tr_b16 v[112:113], v177 offset:14336
  ds_read_b64_tr_b16 v[114:115], v177 offset:16128
  ds_read_b64_tr_b16 v[116:117], v177 offset:14400
  ds_read_b64_tr_b16 v[118:119], v177 offset:16192
  v_mfma_f32_32x32x16_bf16 v[16:31], v[144:147], v[172:175], v[16:31]
  ds_read_b64_tr_b16 v[120:121], v177 offset:14464
  ds_read_b64_tr_b16 v[122:123], v177 offset:16256
  ds_read_b64_tr_b16 v[124:125], v177 offset:14528
  ds_read_b64_tr_b16 v[126:127], v177 offset:16320
  v_mfma_f32_32x32x16_bf16 v[32:47], v[148:151], v[172:175], v[32:47]
  ds_read_b64_tr_b16 v[128:129], v177 offset:14592
  ds_read_b64_tr_b16 v[130:131], v177 offset:16384
  ds_read_b64_tr_b16 v[132:133], v177 offset:14656
  ds_read_b64_tr_b16 v[134:135], v177 offset:16448
  v_mfma_f32_32x32x16_bf16 v[48:63], v[152:155], v[172:175], v[48:63]
  ds_read_b64_tr_b16 v[136:137], v177 offset:14720
  ds_read_b64_tr_b16 v[138:139], v177 offset:16512
  v_mfma_f32_32x32x16_bf16 v[64:79], v[156:159], v[172:175], v[64:79]
  v_mfma_f32_32x32x16_bf16 v[80:95], v[160:163], v[172:175], v[80:95]
  v_mfma_f32_32x32x16_bf16 v[96:111], v[164:167], v[172:175], v[96:111]
  s_waitcnt lgkmcnt(12)
  v_mfma_f32_32x32x16_bf16 v[0:15], v[112:115], v[168:171], v[0:15]
  ds_read_b128 v[172:175], v183
  ds_read_b64_tr_b16 v[140:141], v177 offset:21504
  ds_read_b64_tr_b16 v[142:143], v177 offset:23296
  s_waitcnt lgkmcnt(13)
  ds_read_b64_tr_b16 v[144:145], v177 offset:21568
  ds_read_b64_tr_b16 v[146:147], v177 offset:23360
  v_mfma_f32_32x32x16_bf16 v[16:31], v[116:119], v[168:171], v[16:31]
  s_waitcnt lgkmcnt(13)
  ds_read_b64_tr_b16 v[148:149], v177 offset:21632
  ds_read_b64_tr_b16 v[150:151], v177 offset:23424
  s_waitcnt lgkmcnt(13)
  ds_read_b64_tr_b16 v[152:153], v177 offset:21696
  ds_read_b64_tr_b16 v[154:155], v177 offset:23488
  v_mfma_f32_32x32x16_bf16 v[32:47], v[120:123], v[168:171], v[32:47]
  s_waitcnt lgkmcnt(13)
  ds_read_b64_tr_b16 v[156:157], v177 offset:21760
  ds_read_b64_tr_b16 v[158:159], v177 offset:23552
  s_waitcnt lgkmcnt(13)
  ds_read_b64_tr_b16 v[160:161], v177 offset:21824
  ds_read_b64_tr_b16 v[162:163], v177 offset:23616
  v_mfma_f32_32x32x16_bf16 v[48:63], v[124:127], v[168:171], v[48:63]
  s_waitcnt lgkmcnt(13)
  ds_read_b64_tr_b16 v[164:165], v177 offset:21888
  ds_read_b64_tr_b16 v[166:167], v177 offset:23680
  v_mfma_f32_32x32x16_bf16 v[64:79], v[128:131], v[168:171], v[64:79]
  v_mfma_f32_32x32x16_bf16 v[80:95], v[132:135], v[168:171], v[80:95]
  v_mfma_f32_32x32x16_bf16 v[96:111], v[136:139], v[168:171], v[96:111]
  s_waitcnt lgkmcnt(0)
  s_waitcnt vmcnt(26)
  s_barrier
  s_add_u32 s40, s39, 512
  s_lshl_b32 s41, s25, 12
  s_add_u32 m0, s41, 73728
  s_nop 0
  buffer_load_dwordx4 v185, s[12:15], s40 offen lds
  s_add_u32 s40, s39, 9728
  s_lshl_b32 s41, s25, 12
  s_add_u32 m0, s41, 74752
  s_nop 0
  buffer_load_dwordx4 v186, s[12:15], s40 offen lds
  s_add_u32 s40, s39, 18944
  s_lshl_b32 s41, s25, 12
  s_add_u32 m0, s41, 75776
  s_nop 0
  buffer_load_dwordx4 v185, s[12:15], s40 offen lds
  s_add_u32 s40, s39, 28160
  s_lshl_b32 s41, s25, 12
  s_add_u32 m0, s41, 76800
  s_nop 0
  buffer_load_dwordx4 v186, s[12:15], s40 offen lds
  v_mfma_f32_32x32x16_bf16 v[0:15], v[140:143], v[172:175], v[0:15]
  ds_read_b128 v[168:171], v181
  ds_read_b64_tr_b16 v[112:113], v178 offset:14336
  ds_read_b64_tr_b16 v[114:115], v178 offset:16128
  ds_read_b64_tr_b16 v[116:117], v178 offset:14400
  ds_read_b64_tr_b16 v[118:119], v178 offset:16192
  v_mfma_f32_32x32x16_bf16 v[16:31], v[144:147], v[172:175], v[16:31]
  ds_read_b64_tr_b16 v[120:121], v178 offset:14464
  ds_read_b64_tr_b16 v[122:123], v178 offset:16256
  ds_read_b64_tr_b16 v[124:125], v178 offset:14528
  ds_read_b64_tr_b16 v[126:127], v178 offset:16320
  v_mfma_f32_32x32x16_bf16 v[32:47], v[148:151], v[172:175], v[32:47]
  ds_read_b64_tr_b16 v[128:129], v178 offset:14592
  ds_read_b64_tr_b16 v[130:131], v178 offset:16384
  ds_read_b64_tr_b16 v[132:133], v178 offset:14656
  ds_read_b64_tr_b16 v[134:135], v178 offset:16448
  v_mfma_f32_32x32x16_bf16 v[48:63], v[152:155], v[172:175], v[48:63]
  ds_read_b64_tr_b16 v[136:137], v178 offset:14720
  ds_read_b64_tr_b16 v[138:139], v178 offset:16512
  v_mfma_f32_32x32x16_bf16 v[64:79], v[156:159], v[172:175], v[64:79]
  v_mfma_f32_32x32x16_bf16 v[80:95], v[160:163], v[172:175], v[80:95]
  v_mfma_f32_32x32x16_bf16 v[96:111], v[164:167], v[172:175], v[96:111]
  s_waitcnt lgkmcnt(12)
  v_mfma_f32_32x32x16_bf16 v[0:15], v[112:115], v[168:171], v[0:15]
  ds_read_b128 v[172:175], v184
  ds_read_b64_tr_b16 v[140:141], v178 offset:21504
  ds_read_b64_tr_b16 v[142:143], v178 offset:23296
  s_waitcnt lgkmcnt(13)
  ds_read_b64_tr_b16 v[144:145], v178 offset:21568
  ds_read_b64_tr_b16 v[146:147], v178 offset:23360
  v_mfma_f32_32x32x16_bf16 v[16:31], v[116:119], v[168:171], v[16:31]
  s_waitcnt lgkmcnt(13)
  ds_read_b64_tr_b16 v[148:149], v178 offset:21632
  ds_read_b64_tr_b16 v[150:151], v178 offset:23424
  s_waitcnt lgkmcnt(13)
  ds_read_b64_tr_b16 v[152:153], v178 offset:21696
  ds_read_b64_tr_b16 v[154:155], v178 offset:23488
  v_mfma_f32_32x32x16_bf16 v[32:47], v[120:123], v[168:171], v[32:47]
  s_waitcnt lgkmcnt(13)
  ds_read_b64_tr_b16 v[156:157], v178 offset:21760
  ds_read_b64_tr_b16 v[158:159], v178 offset:23552
  s_waitcnt lgkmcnt(13)
  ds_read_b64_tr_b16 v[160:161], v178 offset:21824
  ds_read_b64_tr_b16 v[162:163], v178 offset:23616
  v_mfma_f32_32x32x16_bf16 v[48:63], v[124:127], v[168:171], v[48:63]
  s_waitcnt lgkmcnt(13)
  ds_read_b64_tr_b16 v[164:165], v178 offset:21888
  ds_read_b64_tr_b16 v[166:167], v178 offset:23680
  v_mfma_f32_32x32x16_bf16 v[64:79], v[128:131], v[168:171], v[64:79]
  v_mfma_f32_32x32x16_bf16 v[80:95], v[132:135], v[168:171], v[80:95]
  v_mfma_f32_32x32x16_bf16 v[96:111], v[136:139], v[168:171], v[96:111]
  s_waitcnt lgkmcnt(0)
  s_waitcnt vmcnt(4)
  s_barrier
  s_add_u32 s40, s39, 640
  s_lshl_b32 s41, s25, 12
  s_add_u32 m0, s41, 118784
  s_nop 0
  buffer_load_dwordx4 v185, s[12:15], s40 offen lds
  s_add_u32 s40, s39, 9856
  s_lshl_b32 s41, s25, 12
  s_add_u32 m0, s41, 119808
  s_nop 0
  buffer_load_dwordx4 v186, s[12:15], s40 offen lds
  s_add_u32 s40, s39, 19072
  s_lshl_b32 s41, s25, 12
  s_add_u32 m0, s41, 120832
  s_nop 0
  buffer_load_dwordx4 v185, s[12:15], s40 offen lds
  s_add_u32 s40, s39, 28288
  s_lshl_b32 s41, s25, 12
  s_add_u32 m0, s41, 121856
  s_nop 0
  buffer_load_dwordx4 v186, s[12:15], s40 offen lds
  v_mfma_f32_32x32x16_bf16 v[0:15], v[140:143], v[172:175], v[0:15]
  ds_read_b128 v[168:171], v179
  ds_read_b64_tr_b16 v[112:113], v176 offset:14336
  ds_read_b64_tr_b16 v[114:115], v176 offset:16128
  ds_read_b64_tr_b16 v[116:117], v176 offset:14400
  ds_read_b64_tr_b16 v[118:119], v176 offset:16192
  v_mfma_f32_32x32x16_bf16 v[16:31], v[144:147], v[172:175], v[16:31]
  ds_read_b64_tr_b16 v[120:121], v176 offset:14464
  ds_read_b64_tr_b16 v[122:123], v176 offset:16256
  ds_read_b64_tr_b16 v[124:125], v176 offset:14528
  ds_read_b64_tr_b16 v[126:127], v176 offset:16320
  v_mfma_f32_32x32x16_bf16 v[32:47], v[148:151], v[172:175], v[32:47]
  ds_read_b64_tr_b16 v[128:129], v176 offset:14592
  ds_read_b64_tr_b16 v[130:131], v176 offset:16384
  ds_read_b64_tr_b16 v[132:133], v176 offset:14656
  ds_read_b64_tr_b16 v[134:135], v176 offset:16448
  v_mfma_f32_32x32x16_bf16 v[48:63], v[152:155], v[172:175], v[48:63]
  ds_read_b64_tr_b16 v[136:137], v176 offset:14720
  ds_read_b64_tr_b16 v[138:139], v176 offset:16512
  v_mfma_f32_32x32x16_bf16 v[64:79], v[156:159], v[172:175], v[64:79]
  v_mfma_f32_32x32x16_bf16 v[80:95], v[160:163], v[172:175], v[80:95]
  v_mfma_f32_32x32x16_bf16 v[96:111], v[164:167], v[172:175], v[96:111]
  s_waitcnt lgkmcnt(12)
  v_mfma_f32_32x32x16_bf16 v[0:15], v[112:115], v[168:171], v[0:15]
  ds_read_b128 v[172:175], v182
  ds_read_b64_tr_b16 v[140:141], v176 offset:21504
  ds_read_b64_tr_b16 v[142:143], v176 offset:23296
  s_waitcnt lgkmcnt(13)
  ds_read_b64_tr_b16 v[144:145], v176 offset:21568
  ds_read_b64_tr_b16 v[146:147], v176 offset:23360
  v_mfma_f32_32x32x16_bf16 v[16:31], v[116:119], v[168:171], v[16:31]
  s_waitcnt lgkmcnt(13)
  ds_read_b64_tr_b16 v[148:149], v176 offset:21632
  ds_read_b64_tr_b16 v[150:151], v176 offset:23424
  s_waitcnt lgkmcnt(13)
  ds_read_b64_tr_b16 v[152:153], v176 offset:21696
  ds_read_b64_tr_b16 v[154:155], v176 offset:23488
  v_mfma_f32_32x32x16_bf16 v[32:47], v[120:123], v[168:171], v[32:47]
  s_waitcnt lgkmcnt(13)
  ds_read_b64_tr_b16 v[156:157], v176 offset:21760
  ds_read_b64_tr_b16 v[158:159], v176 offset:23552
  s_waitcnt lgkmcnt(13)
  ds_read_b64_tr_b16 v[160:161], v176 offset:21824
  ds_read_b64_tr_b16 v[162:163], v176 offset:23616
  v_mfma_f32_32x32x16_bf16 v[48:63], v[124:127], v[168:171], v[48:63]
  s_waitcnt lgkmcnt(13)
  ds_read_b64_tr_b16 v[164:165], v176 offset:21888
  ds_read_b64_tr_b16 v[166:167], v176 offset:23680
  v_mfma_f32_32x32x16_bf16 v[64:79], v[128:131], v[168:171], v[64:79]
  v_mfma_f32_32x32x16_bf16 v[80:95], v[132:135], v[168:171], v[80:95]
  v_mfma_f32_32x32x16_bf16 v[96:111], v[136:139], v[168:171], v[96:111]
  s_waitcnt lgkmcnt(0)
  s_waitcnt vmcnt(4)
  s_barrier
  s_add_u32 s40, s39, 768
  s_lshl_b32 s41, s25, 12
  s_add_u32 m0, s41, 28672
  s_nop 0
  buffer_load_dwordx4 v185, s[12:15], s40 offen lds
  s_add_u32 s40, s39, 9984
  s_lshl_b32 s41, s25, 12
  s_add_u32 m0, s41, 29696
  s_nop 0
  buffer_load_dwordx4 v186, s[12:15], s40 offen lds
  s_add_u32 s40, s39, 19200
  s_lshl_b32 s41, s25, 12
  s_add_u32 m0, s41, 30720
  s_nop 0
  buffer_load_dwordx4 v185, s[12:15], s40 offen lds
  s_add_u32 s40, s39, 28416
  s_lshl_b32 s41, s25, 12
  s_add_u32 m0, s41, 31744
  s_nop 0
  buffer_load_dwordx4 v186, s[12:15], s40 offen lds
  v_mfma_f32_32x32x16_bf16 v[0:15], v[140:143], v[172:175], v[0:15]
  ds_read_b128 v[168:171], v180
  ds_read_b64_tr_b16 v[112:113], v177 offset:14336
  ds_read_b64_tr_b16 v[114:115], v177 offset:16128
  ds_read_b64_tr_b16 v[116:117], v177 offset:14400
  ds_read_b64_tr_b16 v[118:119], v177 offset:16192
  v_mfma_f32_32x32x16_bf16 v[16:31], v[144:147], v[172:175], v[16:31]
  ds_read_b64_tr_b16 v[120:121], v177 offset:14464
  ds_read_b64_tr_b16 v[122:123], v177 offset:16256
  ds_read_b64_tr_b16 v[124:125], v177 offset:14528
  ds_read_b64_tr_b16 v[126:127], v177 offset:16320
  v_mfma_f32_32x32x16_bf16 v[32:47], v[148:151], v[172:175], v[32:47]
  ds_read_b64_tr_b16 v[128:129], v177 offset:14592
  ds_read_b64_tr_b16 v[130:131], v177 offset:16384
  ds_read_b64_tr_b16 v[132:133], v177 offset:14656
  ds_read_b64_tr_b16 v[134:135], v177 offset:16448
  v_mfma_f32_32x32x16_bf16 v[48:63], v[152:155], v[172:175], v[48:63]
  ds_read_b64_tr_b16 v[136:137], v177 offset:14720
  ds_read_b64_tr_b16 v[138:139], v177 offset:16512
  v_mfma_f32_32x32x16_bf16 v[64:79], v[156:159], v[172:175], v[64:79]
  v_mfma_f32_32x32x16_bf16 v[80:95], v[160:163], v[172:175], v[80:95]
  v_mfma_f32_32x32x16_bf16 v[96:111], v[164:167], v[172:175], v[96:111]
  s_waitcnt lgkmcnt(12)
  v_mfma_f32_32x32x16_bf16 v[0:15], v[112:115], v[168:171], v[0:15]
  ds_read_b128 v[172:175], v183
  ds_read_b64_tr_b16 v[140:141], v177 offset:21504
  ds_read_b64_tr_b16 v[142:143], v177 offset:23296
  s_waitcnt lgkmcnt(13)
  ds_read_b64_tr_b16 v[144:145], v177 offset:21568
  ds_read_b64_tr_b16 v[146:147], v177 offset:23360
  v_mfma_f32_32x32x16_bf16 v[16:31], v[116:119], v[168:171], v[16:31]
  s_waitcnt lgkmcnt(13)
  ds_read_b64_tr_b16 v[148:149], v177 offset:21632
  ds_read_b64_tr_b16 v[150:151], v177 offset:23424
  s_waitcnt lgkmcnt(13)
  ds_read_b64_tr_b16 v[152:153], v177 offset:21696
  ds_read_b64_tr_b16 v[154:155], v177 offset:23488
  v_mfma_f32_32x32x16_bf16 v[32:47], v[120:123], v[168:171], v[32:47]
  s_waitcnt lgkmcnt(13)
  ds_read_b64_tr_b16 v[156:157], v177 offset:21760
  ds_read_b64_tr_b16 v[158:159], v177 offset:23552
  s_waitcnt lgkmcnt(13)
  ds_read_b64_tr_b16 v[160:161], v177 offset:21824
  ds_read_b64_tr_b16 v[162:163], v177 offset:23616
  v_mfma_f32_32x32x16_bf16 v[48:63], v[124:127], v[168:171], v[48:63]
  s_waitcnt lgkmcnt(13)
  ds_read_b64_tr_b16 v[164:165], v177 offset:21888
  ds_read_b64_tr_b16 v[166:167], v177 offset:23680
  v_mfma_f32_32x32x16_bf16 v[64:79], v[128:131], v[168:171], v[64:79]
  v_mfma_f32_32x32x16_bf16 v[80:95], v[132:135], v[168:171], v[80:95]
  v_mfma_f32_32x32x16_bf16 v[96:111], v[136:139], v[168:171], v[96:111]
  s_waitcnt lgkmcnt(0)
  s_waitcnt vmcnt(4)
  s_barrier
  s_add_u32 s40, s39, 896
  s_lshl_b32 s41, s25, 12
  s_add_u32 m0, s41, 73728
  s_nop 0
  buffer_load_dwordx4 v185, s[12:15], s40 offen lds
  s_add_u32 s40, s39, 10112
  s_lshl_b32 s41, s25, 12
  s_add_u32 m0, s41, 74752
  s_nop 0
  buffer_load_dwordx4 v186, s[12:15], s40 offen lds
  s_add_u32 s40, s39, 19328
  s_lshl_b32 s41, s25, 12
  s_add_u32 m0, s41, 75776
  s_nop 0
  buffer_load_dwordx4 v185, s[12:15], s40 offen lds
  s_add_u32 s40, s39, 28544
  s_lshl_b32 s41, s25, 12
  s_add_u32 m0, s41, 76800
  s_nop 0
  buffer_load_dwordx4 v186, s[12:15], s40 offen lds
  v_mfma_f32_32x32x16_bf16 v[0:15], v[140:143], v[172:175], v[0:15]
  ds_read_b128 v[168:171], v181
  ds_read_b64_tr_b16 v[112:113], v178 offset:14336
  ds_read_b64_tr_b16 v[114:115], v178 offset:16128
  ds_read_b64_tr_b16 v[116:117], v178 offset:14400
  ds_read_b64_tr_b16 v[118:119], v178 offset:16192
  v_mfma_f32_32x32x16_bf16 v[16:31], v[144:147], v[172:175], v[16:31]
  ds_read_b64_tr_b16 v[120:121], v178 offset:14464
  ds_read_b64_tr_b16 v[122:123], v178 offset:16256
  ds_read_b64_tr_b16 v[124:125], v178 offset:14528
  ds_read_b64_tr_b16 v[126:127], v178 offset:16320
  v_mfma_f32_32x32x16_bf16 v[32:47], v[148:151], v[172:175], v[32:47]
  ds_read_b64_tr_b16 v[128:129], v178 offset:14592
  ds_read_b64_tr_b16 v[130:131], v178 offset:16384
  ds_read_b64_tr_b16 v[132:133], v178 offset:14656
  ds_read_b64_tr_b16 v[134:135], v178 offset:16448
  v_mfma_f32_32x32x16_bf16 v[48:63], v[152:155], v[172:175], v[48:63]
  ds_read_b64_tr_b16 v[136:137], v178 offset:14720
  ds_read_b64_tr_b16 v[138:139], v178 offset:16512
  v_mfma_f32_32x32x16_bf16 v[64:79], v[156:159], v[172:175], v[64:79]
  v_mfma_f32_32x32x16_bf16 v[80:95], v[160:163], v[172:175], v[80:95]
  v_mfma_f32_32x32x16_bf16 v[96:111], v[164:167], v[172:175], v[96:111]
  s_waitcnt lgkmcnt(12)
  v_mfma_f32_32x32x16_bf16 v[0:15], v[112:115], v[168:171], v[0:15]
  ds_read_b128 v[172:175], v184
  ds_read_b64_tr_b16 v[140:141], v178 offset:21504
  ds_read_b64_tr_b16 v[142:143], v178 offset:23296
  s_waitcnt lgkmcnt(13)
  ds_read_b64_tr_b16 v[144:145], v178 offset:21568
  ds_read_b64_tr_b16 v[146:147], v178 offset:23360
  v_mfma_f32_32x32x16_bf16 v[16:31], v[116:119], v[168:171], v[16:31]
  s_waitcnt lgkmcnt(13)
  ds_read_b64_tr_b16 v[148:149], v178 offset:21632
  ds_read_b64_tr_b16 v[150:151], v178 offset:23424
  s_waitcnt lgkmcnt(13)
  ds_read_b64_tr_b16 v[152:153], v178 offset:21696
  ds_read_b64_tr_b16 v[154:155], v178 offset:23488
  v_mfma_f32_32x32x16_bf16 v[32:47], v[120:123], v[168:171], v[32:47]
  s_waitcnt lgkmcnt(13)
  ds_read_b64_tr_b16 v[156:157], v178 offset:21760
  ds_read_b64_tr_b16 v[158:159], v178 offset:23552
  s_waitcnt lgkmcnt(13)
  ds_read_b64_tr_b16 v[160:161], v178 offset:21824
  ds_read_b64_tr_b16 v[162:163], v178 offset:23616
  v_mfma_f32_32x32x16_bf16 v[48:63], v[124:127], v[168:171], v[48:63]
  s_waitcnt lgkmcnt(13)
  ds_read_b64_tr_b16 v[164:165], v178 offset:21888
  ds_read_b64_tr_b16 v[166:167], v178 offset:23680
  v_mfma_f32_32x32x16_bf16 v[64:79], v[128:131], v[168:171], v[64:79]
  v_mfma_f32_32x32x16_bf16 v[80:95], v[132:135], v[168:171], v[80:95]
  v_mfma_f32_32x32x16_bf16 v[96:111], v[136:139], v[168:171], v[96:111]
  s_waitcnt lgkmcnt(0)
  s_waitcnt vmcnt(4)
  s_barrier
  s_add_u32 s40, s39, 1024
  s_lshl_b32 s41, s25, 12
  s_add_u32 m0, s41, 118784
  s_nop 0
  buffer_load_dwordx4 v185, s[12:15], s40 offen lds
  s_add_u32 s40, s39, 10240
  s_lshl_b32 s41, s25, 12
  s_add_u32 m0, s41, 119808
  s_nop 0
  buffer_load_dwordx4 v186, s[12:15], s40 offen lds
  s_add_u32 s40, s39, 19456
  s_lshl_b32 s41, s25, 12
  s_add_u32 m0, s41, 120832
  s_nop 0
  buffer_load_dwordx4 v185, s[12:15], s40 offen lds
  s_add_u32 s40, s39, 28672
  s_lshl_b32 s41, s25, 12
  s_add_u32 m0, s41, 121856
  s_nop 0
  buffer_load_dwordx4 v186, s[12:15], s40 offen lds
  v_mfma_f32_32x32x16_bf16 v[0:15], v[140:143], v[172:175], v[0:15]
  ds_read_b128 v[168:171], v179
  ds_read_b64_tr_b16 v[112:113], v176 offset:14336
  ds_read_b64_tr_b16 v[114:115], v176 offset:16128
  ds_read_b64_tr_b16 v[116:117], v176 offset:14400
  ds_read_b64_tr_b16 v[118:119], v176 offset:16192
  v_mfma_f32_32x32x16_bf16 v[16:31], v[144:147], v[172:175], v[16:31]
  ds_read_b64_tr_b16 v[120:121], v176 offset:14464
  ds_read_b64_tr_b16 v[122:123], v176 offset:16256
  ds_read_b64_tr_b16 v[124:125], v176 offset:14528
  ds_read_b64_tr_b16 v[126:127], v176 offset:16320
  v_mfma_f32_32x32x16_bf16 v[32:47], v[148:151], v[172:175], v[32:47]
  ds_read_b64_tr_b16 v[128:129], v176 offset:14592
  ds_read_b64_tr_b16 v[130:131], v176 offset:16384
  ds_read_b64_tr_b16 v[132:133], v176 offset:14656
  ds_read_b64_tr_b16 v[134:135], v176 offset:16448
  v_mfma_f32_32x32x16_bf16 v[48:63], v[152:155], v[172:175], v[48:63]
  ds_read_b64_tr_b16 v[136:137], v176 offset:14720
  ds_read_b64_tr_b16 v[138:139], v176 offset:16512
  v_mfma_f32_32x32x16_bf16 v[64:79], v[156:159], v[172:175], v[64:79]
  v_mfma_f32_32x32x16_bf16 v[80:95], v[160:163], v[172:175], v[80:95]
  v_mfma_f32_32x32x16_bf16 v[96:111], v[164:167], v[172:175], v[96:111]
  s_waitcnt lgkmcnt(12)
  v_mfma_f32_32x32x16_bf16 v[0:15], v[112:115], v[168:171], v[0:15]
  ds_read_b128 v[172:175], v182
  ds_read_b64_tr_b16 v[140:141], v176 offset:21504
  ds_read_b64_tr_b16 v[142:143], v176 offset:23296
  s_waitcnt lgkmcnt(13)
  ds_read_b64_tr_b16 v[144:145], v176 offset:21568
  ds_read_b64_tr_b16 v[146:147], v176 offset:23360
  v_mfma_f32_32x32x16_bf16 v[16:31], v[116:119], v[168:171], v[16:31]
  s_waitcnt lgkmcnt(13)
  ds_read_b64_tr_b16 v[148:149], v176 offset:21632
  ds_read_b64_tr_b16 v[150:151], v176 offset:23424
  s_waitcnt lgkmcnt(13)
  ds_read_b64_tr_b16 v[152:153], v176 offset:21696
  ds_read_b64_tr_b16 v[154:155], v176 offset:23488
  v_mfma_f32_32x32x16_bf16 v[32:47], v[120:123], v[168:171], v[32:47]
  s_waitcnt lgkmcnt(13)
  ds_read_b64_tr_b16 v[156:157], v176 offset:21760
  ds_read_b64_tr_b16 v[158:159], v176 offset:23552
  s_waitcnt lgkmcnt(13)
  ds_read_b64_tr_b16 v[160:161], v176 offset:21824
  ds_read_b64_tr_b16 v[162:163], v176 offset:23616
  v_mfma_f32_32x32x16_bf16 v[48:63], v[124:127], v[168:171], v[48:63]
  s_waitcnt lgkmcnt(13)
  ds_read_b64_tr_b16 v[164:165], v176 offset:21888
  ds_read_b64_tr_b16 v[166:167], v176 offset:23680
  v_mfma_f32_32x32x16_bf16 v[64:79], v[128:131], v[168:171], v[64:79]
  v_mfma_f32_32x32x16_bf16 v[80:95], v[132:135], v[168:171], v[80:95]
  v_mfma_f32_32x32x16_bf16 v[96:111], v[136:139], v[168:171], v[96:111]
  s_waitcnt lgkmcnt(0)
  s_waitcnt vmcnt(4)
  s_barrier
  v_mfma_f32_32x32x16_bf16 v[0:15], v[140:143], v[172:175], v[0:15]
  ds_read_b128 v[168:171], v180
  ds_read_b64_tr_b16 v[112:113], v177 offset:14336
  ds_read_b64_tr_b16 v[114:115], v177 offset:16128
  ds_read_b64_tr_b16 v[116:117], v177 offset:14400
  ds_read_b64_tr_b16 v[118:119], v177 offset:16192
  v_mfma_f32_32x32x16_bf16 v[16:31], v[144:147], v[172:175], v[16:31]
  ds_read_b64_tr_b16 v[120:121], v177 offset:14464
  ds_read_b64_tr_b16 v[122:123], v177 offset:16256
  ds_read_b64_tr_b16 v[124:125], v177 offset:14528
  ds_read_b64_tr_b16 v[126:127], v177 offset:16320
  v_mfma_f32_32x32x16_bf16 v[32:47], v[148:151], v[172:175], v[32:47]
  ds_read_b64_tr_b16 v[128:129], v177 offset:14592
  ds_read_b64_tr_b16 v[130:131], v177 offset:16384
  ds_read_b64_tr_b16 v[132:133], v177 offset:14656
  ds_read_b64_tr_b16 v[134:135], v177 offset:16448
  v_mfma_f32_32x32x16_bf16 v[48:63], v[152:155], v[172:175], v[48:63]
  ds_read_b64_tr_b16 v[136:137], v177 offset:14720
  ds_read_b64_tr_b16 v[138:139], v177 offset:16512
  v_mfma_f32_32x32x16_bf16 v[64:79], v[156:159], v[172:175], v[64:79]
  v_mfma_f32_32x32x16_bf16 v[80:95], v[160:163], v[172:175], v[80:95]
  v_mfma_f32_32x32x16_bf16 v[96:111], v[164:167], v[172:175], v[96:111]
  s_waitcnt lgkmcnt(12)
  v_mfma_f32_32x32x16_bf16 v[0:15], v[112:115], v[168:171], v[0:15]
  ds_read_b128 v[172:175], v183
  ds_read_b64_tr_b16 v[140:141], v177 offset:21504
  ds_read_b64_tr_b16 v[142:143], v177 offset:23296
  s_waitcnt lgkmcnt(13)
  ds_read_b64_tr_b16 v[144:145], v177 offset:21568
  ds_read_b64_tr_b16 v[146:147], v177 offset:23360
  v_mfma_f32_32x32x16_bf16 v[16:31], v[116:119], v[168:171], v[16:31]
  s_waitcnt lgkmcnt(13)
  ds_read_b64_tr_b16 v[148:149], v177 offset:21632
  ds_read_b64_tr_b16 v[150:151], v177 offset:23424
  s_waitcnt lgkmcnt(13)
  ds_read_b64_tr_b16 v[152:153], v177 offset:21696
  ds_read_b64_tr_b16 v[154:155], v177 offset:23488
  v_mfma_f32_32x32x16_bf16 v[32:47], v[120:123], v[168:171], v[32:47]
  s_waitcnt lgkmcnt(13)
  ds_read_b64_tr_b16 v[156:157], v177 offset:21760
  ds_read_b64_tr_b16 v[158:159], v177 offset:23552
  s_waitcnt lgkmcnt(13)
  ds_read_b64_tr_b16 v[160:161], v177 offset:21824
  ds_read_b64_tr_b16 v[162:163], v177 offset:23616
  v_mfma_f32_32x32x16_bf16 v[48:63], v[124:127], v[168:171], v[48:63]
  s_waitcnt lgkmcnt(13)
  ds_read_b64_tr_b16 v[164:165], v177 offset:21888
  ds_read_b64_tr_b16 v[166:167], v177 offset:23680
  v_mfma_f32_32x32x16_bf16 v[64:79], v[128:131], v[168:171], v[64:79]
  v_mfma_f32_32x32x16_bf16 v[80:95], v[132:135], v[168:171], v[80:95]
  v_mfma_f32_32x32x16_bf16 v[96:111], v[136:139], v[168:171], v[96:111]
  s_waitcnt lgkmcnt(0)
  s_waitcnt vmcnt(0)
  s_barrier
  v_mfma_f32_32x32x16_bf16 v[0:15], v[140:143], v[172:175], v[0:15]
  ds_read_b128 v[168:171], v181
  ds_read_b64_tr_b16 v[112:113], v178 offset:14336
  ds_read_b64_tr_b16 v[114:115], v178 offset:16128
  ds_read_b64_tr_b16 v[116:117], v178 offset:14400
  ds_read_b64_tr_b16 v[118:119], v178 offset:16192
  v_mfma_f32_32x32x16_bf16 v[16:31], v[144:147], v[172:175], v[16:31]
  ds_read_b64_tr_b16 v[120:121], v178 offset:14464
  ds_read_b64_tr_b16 v[122:123], v178 offset:16256
  ds_read_b64_tr_b16 v[124:125], v178 offset:14528
  ds_read_b64_tr_b16 v[126:127], v178 offset:16320
  v_mfma_f32_32x32x16_bf16 v[32:47], v[148:151], v[172:175], v[32:47]
  ds_read_b64_tr_b16 v[128:129], v178 offset:14592
  ds_read_b64_tr_b16 v[130:131], v178 offset:16384
  ds_read_b64_tr_b16 v[132:133], v178 offset:14656
  ds_read_b64_tr_b16 v[134:135], v178 offset:16448
  v_mfma_f32_32x32x16_bf16 v[48:63], v[152:155], v[172:175], v[48:63]
  ds_read_b64_tr_b16 v[136:137], v178 offset:14720
  ds_read_b64_tr_b16 v[138:139], v178 offset:16512
  v_mfma_f32_32x32x16_bf16 v[64:79], v[156:159], v[172:175], v[64:79]
  v_mfma_f32_32x32x16_bf16 v[80:95], v[160:163], v[172:175], v[80:95]
  v_mfma_f32_32x32x16_bf16 v[96:111], v[164:167], v[172:175], v[96:111]
  s_waitcnt lgkmcnt(12)
  v_mfma_f32_32x32x16_bf16 v[0:15], v[112:115], v[168:171], v[0:15]
  ds_read_b128 v[172:175], v184
  ds_read_b64_tr_b16 v[140:141], v178 offset:21504
  ds_read_b64_tr_b16 v[142:143], v178 offset:23296
  s_waitcnt lgkmcnt(13)
  ds_read_b64_tr_b16 v[144:145], v178 offset:21568
  ds_read_b64_tr_b16 v[146:147], v178 offset:23360
  v_mfma_f32_32x32x16_bf16 v[16:31], v[116:119], v[168:171], v[16:31]
  s_waitcnt lgkmcnt(13)
  ds_read_b64_tr_b16 v[148:149], v178 offset:21632
  ds_read_b64_tr_b16 v[150:151], v178 offset:23424
  s_waitcnt lgkmcnt(13)
  ds_read_b64_tr_b16 v[152:153], v178 offset:21696
  ds_read_b64_tr_b16 v[154:155], v178 offset:23488
  v_mfma_f32_32x32x16_bf16 v[32:47], v[120:123], v[168:171], v[32:47]
  s_waitcnt lgkmcnt(13)
  ds_read_b64_tr_b16 v[156:157], v178 offset:21760
  ds_read_b64_tr_b16 v[158:159], v178 offset:23552
  s_waitcnt lgkmcnt(13)
  ds_read_b64_tr_b16 v[160:161], v178 offset:21824
  ds_read_b64_tr_b16 v[162:163], v178 offset:23616
  v_mfma_f32_32x32x16_bf16 v[48:63], v[124:127], v[168:171], v[48:63]
  s_waitcnt lgkmcnt(13)
  ds_read_b64_tr_b16 v[164:165], v178 offset:21888
  ds_read_b64_tr_b16 v[166:167], v178 offset:23680
  v_mfma_f32_32x32x16_bf16 v[64:79], v[128:131], v[168:171], v[64:79]
  v_mfma_f32_32x32x16_bf16 v[80:95], v[132:135], v[168:171], v[80:95]
  v_mfma_f32_32x32x16_bf16 v[96:111], v[136:139], v[168:171], v[96:111]
  s_waitcnt lgkmcnt(0)
  s_barrier
  v_mfma_f32_32x32x16_bf16 v[0:15], v[140:143], v[172:175], v[0:15]
  v_mfma_f32_32x32x16_bf16 v[16:31], v[144:147], v[172:175], v[16:31]
  v_mfma_f32_32x32x16_bf16 v[32:47], v[148:151], v[172:175], v[32:47]
  v_mfma_f32_32x32x16_bf16 v[48:63], v[152:155], v[172:175], v[48:63]
  v_mfma_f32_32x32x16_bf16 v[64:79], v[156:159], v[172:175], v[64:79]
  v_mfma_f32_32x32x16_bf16 v[80:95], v[160:163], v[172:175], v[80:95]
  v_mfma_f32_32x32x16_bf16 v[96:111], v[164:167], v[172:175], v[96:111]
  s_barrier
  s_lshl_b32 s40, s25, 1
  s_add_u32 s41, s40, 0
  s_mul_i32 s41, s41, 15360
  s_add_u32 s40, s40, 1
  s_mul_i32 s40, s40, 15360
  v_lshlrev_b32 v193, 4, v192
  v_add_u32 v194, s41, v193
  v_add_u32 v195, s40, v193
  ds_write_b128 v194, v[0:3] offset:0
  ds_write_b128 v194, v[4:7] offset:1024
  ds_write_b128 v194, v[8:11] offset:2048
  ds_write_b128 v194, v[12:15] offset:3072
  ds_write_b128 v194, v[16:19] offset:4096
  ds_write_b128 v194, v[36:39] offset:5120
  ds_write_b128 v194, v[40:43] offset:6144
  ds_write_b128 v194, v[44:47] offset:7168
  ds_write_b128 v194, v[48:51] offset:8192
  ds_write_b128 v194, v[52:55] offset:9216
  ds_write_b128 v194, v[72:75] offset:10240
  ds_write_b128 v194, v[76:79] offset:11264
  ds_write_b128 v194, v[80:83] offset:12288
  ds_write_b128 v194, v[84:87] offset:13312
  ds_write_b128 v194, v[88:91] offset:14336
  s_waitcnt lgkmcnt(0)
  s_barrier
  ds_read_b128 v[112:115], v195 offset:0
  ds_read_b128 v[116:119], v195 offset:1024
  ds_read_b128 v[120:123], v195 offset:2048
  ds_read_b128 v[124:127], v195 offset:3072
  ds_read_b128 v[128:131], v195 offset:4096
  ds_read_b128 v[132:135], v195 offset:5120
  ds_read_b128 v[136:139], v195 offset:6144
  ds_read_b128 v[140:143], v195 offset:7168
  ds_read_b128 v[144:147], v195 offset:8192
  ds_read_b128 v[148:151], v195 offset:9216
  ds_read_b128 v[152:155], v195 offset:10240
  ds_read_b128 v[156:159], v195 offset:11264
  ds_read_b128 v[160:163], v195 offset:12288
  ds_read_b128 v[164:167], v195 offset:13312
  ds_read_b128 v[168:171], v195 offset:14336
  s_waitcnt lgkmcnt(14)
  v_add_f32 v16, v112, v16
  v_add_f32 v17, v113, v17
  v_add_f32 v18, v114, v18
  v_add_f32 v19, v115, v19
  s_waitcnt lgkmcnt(13)
  v_add_f32 v20, v116, v20
  v_add_f32 v21, v117, v21
  v_add_f32 v22, v118, v22
  v_add_f32 v23, v119, v23
  s_waitcnt lgkmcnt(12)
  v_add_f32 v24, v120, v24
  v_add_f32 v25, v121, v25
  v_add_f32 v26, v122, v26
  v_add_f32 v27, v123, v27
  s_waitcnt lgkmcnt(11)
  v_add_f32 v28, v124, v28
  v_add_f32 v29, v125, v29
  v_add_f32 v30, v126, v30
  v_add_f32 v31, v127, v31
  s_waitcnt lgkmcnt(10)
  v_add_f32 v32, v128, v32
  v_add_f32 v33, v129, v33
  v_add_f32 v34, v130, v34
  v_add_f32 v35, v131, v35
  s_waitcnt lgkmcnt(9)
  v_add_f32 v52, v132, v52
  v_add_f32 v53, v133, v53
  v_add_f32 v54, v134, v54
  v_add_f32 v55, v135, v55
  s_waitcnt lgkmcnt(8)
  v_add_f32 v56, v136, v56
  v_add_f32 v57, v137, v57
  v_add_f32 v58, v138, v58
  v_add_f32 v59, v139, v59
  s_waitcnt lgkmcnt(7)
  v_add_f32 v60, v140, v60
  v_add_f32 v61, v141, v61
  v_add_f32 v62, v142, v62
  v_add_f32 v63, v143, v63
  s_waitcnt lgkmcnt(6)
  v_add_f32 v64, v144, v64
  v_add_f32 v65, v145, v65
  v_add_f32 v66, v146, v66
  v_add_f32 v67, v147, v67
  s_waitcnt lgkmcnt(5)
  v_add_f32 v68, v148, v68
  v_add_f32 v69, v149, v69
  v_add_f32 v70, v150, v70
  v_add_f32 v71, v151, v71
  s_waitcnt lgkmcnt(4)
  v_add_f32 v88, v152, v88
  v_add_f32 v89, v153, v89
  v_add_f32 v90, v154, v90
  v_add_f32 v91, v155, v91
  s_waitcnt lgkmcnt(3)
  v_add_f32 v92, v156, v92
  v_add_f32 v93, v157, v93
  v_add_f32 v94, v158, v94
  v_add_f32 v95, v159, v95
  s_waitcnt lgkmcnt(2)
  v_add_f32 v96, v160, v96
  v_add_f32 v97, v161, v97
  v_add_f32 v98, v162, v98
  v_add_f32 v99, v163, v99
  s_waitcnt lgkmcnt(1)
  v_add_f32 v100, v164, v100
  v_add_f32 v101, v165, v101
  v_add_f32 v102, v166, v102
  v_add_f32 v103, v167, v103
  s_waitcnt lgkmcnt(0)
  v_add_f32 v104, v168, v104
  v_add_f32 v105, v169, v105
  v_add_f32 v106, v170, v106
  v_add_f32 v107, v171, v107
  s_cmp_eq_u32 s29, 0
  s_cbranch_scc0 k1_epb1
  v_cvt_pk_bf16_f32 v112, v16, v17
  v_cvt_pk_bf16_f32 v113, v18, v19
  v_cvt_pk_bf16_f32 v114, v20, v21
  v_cvt_pk_bf16_f32 v115, v22, v23
  v_cvt_pk_bf16_f32 v116, v24, v25
  v_cvt_pk_bf16_f32 v117, v26, v27
  v_cvt_pk_bf16_f32 v118, v28, v29
  v_cvt_pk_bf16_f32 v119, v30, v31
  v_cvt_pk_bf16_f32 v120, v32, v33
  v_cvt_pk_bf16_f32 v121, v34, v35
  v_cvt_pk_bf16_f32 v122, v52, v53
  v_cvt_pk_bf16_f32 v123, v54, v55
  v_cvt_pk_bf16_f32 v124, v56, v57
  v_cvt_pk_bf16_f32 v125, v58, v59
  v_cvt_pk_bf16_f32 v126, v60, v61
  v_cvt_pk_bf16_f32 v127, v62, v63
  v_cvt_pk_bf16_f32 v128, v64, v65
  v_cvt_pk_bf16_f32 v129, v66, v67
  v_cvt_pk_bf16_f32 v130, v68, v69
  v_cvt_pk_bf16_f32 v131, v70, v71
  v_cvt_pk_bf16_f32 v132, v88, v89
  v_cvt_pk_bf16_f32 v133, v90, v91
  v_cvt_pk_bf16_f32 v134, v92, v93
  v_cvt_pk_bf16_f32 v135, v94, v95
  v_cvt_pk_bf16_f32 v136, v96, v97
  v_cvt_pk_bf16_f32 v137, v98, v99
  v_cvt_pk_bf16_f32 v138, v100, v101
  v_cvt_pk_bf16_f32 v139, v102, v103
  v_cvt_pk_bf16_f32 v140, v104, v105
  v_cvt_pk_bf16_f32 v141, v106, v107
  v_lshlrev_b32 v162, 16, v112
  v_and_b32 v163, 0xffff0000, v112
  v_min_f32 v164, 0, v162
  v_min_f32 v165, 0, v163
  v_mul_f32 v164, 0x3fb8aa3b, v164
  v_mul_f32 v165, 0x3fb8aa3b, v165
  v_exp_f32 v164, v164
  v_exp_f32 v165, v165
  v_max_f32 v162, 0, v162
  v_max_f32 v163, 0, v163
  v_add_f32 v162, v162, v164
  v_add_f32 v163, v163, v165
  v_cvt_pk_bf16_f32 v164, v162, v163
  v_lshlrev_b32 v162, 16, v164
  v_and_b32 v163, 0xffff0000, v164
  v_add_f32 v162, 0x358637bd, v162
  v_add_f32 v163, 0x358637bd, v163
  v_cvt_pk_bf16_f32 v142, v162, v163
  v_lshlrev_b32 v166, 16, v113
  v_and_b32 v167, 0xffff0000, v113
  v_min_f32 v168, 0, v166
  v_min_f32 v169, 0, v167
  v_mul_f32 v168, 0x3fb8aa3b, v168
  v_mul_f32 v169, 0x3fb8aa3b, v169
  v_exp_f32 v168, v168
  v_exp_f32 v169, v169
  v_max_f32 v166, 0, v166
  v_max_f32 v167, 0, v167
  v_add_f32 v166, v166, v168
  v_add_f32 v167, v167, v169
  v_cvt_pk_bf16_f32 v168, v166, v167
  v_lshlrev_b32 v166, 16, v168
  v_and_b32 v167, 0xffff0000, v168
  v_add_f32 v166, 0x358637bd, v166
  v_add_f32 v167, 0x358637bd, v167
  v_cvt_pk_bf16_f32 v143, v166, v167
  v_lshlrev_b32 v162, 16, v114
  v_and_b32 v163, 0xffff0000, v114
  v_min_f32 v164, 0, v162
  v_min_f32 v165, 0, v163
  v_mul_f32 v164, 0x3fb8aa3b, v164
  v_mul_f32 v165, 0x3fb8aa3b, v165
  v_exp_f32 v164, v164
  v_exp_f32 v165, v165
  v_max_f32 v162, 0, v162
  v_max_f32 v163, 0, v163
  v_add_f32 v162, v162, v164
  v_add_f32 v163, v163, v165
  v_cvt_pk_bf16_f32 v164, v162, v163
  v_lshlrev_b32 v162, 16, v164
  v_and_b32 v163, 0xffff0000, v164
  v_add_f32 v162, 0x358637bd, v162
  v_add_f32 v163, 0x358637bd, v163
  v_cvt_pk_bf16_f32 v144, v162, v163
  v_lshlrev_b32 v166, 16, v115
  v_and_b32 v167, 0xffff0000, v115
  v_min_f32 v168, 0, v166
  v_min_f32 v169, 0, v167
  v_mul_f32 v168, 0x3fb8aa3b, v168
  v_mul_f32 v169, 0x3fb8aa3b, v169
  v_exp_f32 v168, v168
  v_exp_f32 v169, v169
  v_max_f32 v166, 0, v166
  v_max_f32 v167, 0, v167
  v_add_f32 v166, v166, v168
  v_add_f32 v167, v167, v169
  v_cvt_pk_bf16_f32 v168, v166, v167
  v_lshlrev_b32 v166, 16, v168
  v_and_b32 v167, 0xffff0000, v168
  v_add_f32 v166, 0x358637bd, v166
  v_add_f32 v167, 0x358637bd, v167
  v_cvt_pk_bf16_f32 v145, v166, v167
  v_lshlrev_b32 v162, 16, v116
  v_and_b32 v163, 0xffff0000, v116
  v_min_f32 v164, 0, v162
  v_min_f32 v165, 0, v163
  v_mul_f32 v164, 0x3fb8aa3b, v164
  v_mul_f32 v165, 0x3fb8aa3b, v165
  v_exp_f32 v164, v164
  v_exp_f32 v165, v165
  v_max_f32 v162, 0, v162
  v_max_f32 v163, 0, v163
  v_add_f32 v162, v162, v164
  v_add_f32 v163, v163, v165
  v_cvt_pk_bf16_f32 v164, v162, v163
  v_lshlrev_b32 v162, 16, v164
  v_and_b32 v163, 0xffff0000, v164
  v_add_f32 v162, 0x358637bd, v162
  v_add_f32 v163, 0x358637bd, v163
  v_cvt_pk_bf16_f32 v146, v162, v163
  v_lshlrev_b32 v166, 16, v117
  v_and_b32 v167, 0xffff0000, v117
  v_min_f32 v168, 0, v166
  v_min_f32 v169, 0, v167
  v_mul_f32 v168, 0x3fb8aa3b, v168
  v_mul_f32 v169, 0x3fb8aa3b, v169
  v_exp_f32 v168, v168
  v_exp_f32 v169, v169
  v_max_f32 v166, 0, v166
  v_max_f32 v167, 0, v167
  v_add_f32 v166, v166, v168
  v_add_f32 v167, v167, v169
  v_cvt_pk_bf16_f32 v168, v166, v167
  v_lshlrev_b32 v166, 16, v168
  v_and_b32 v167, 0xffff0000, v168
  v_add_f32 v166, 0x358637bd, v166
  v_add_f32 v167, 0x358637bd, v167
  v_cvt_pk_bf16_f32 v147, v166, v167
  v_lshlrev_b32 v162, 16, v118
  v_and_b32 v163, 0xffff0000, v118
  v_min_f32 v164, 0, v162
  v_min_f32 v165, 0, v163
  v_mul_f32 v164, 0x3fb8aa3b, v164
  v_mul_f32 v165, 0x3fb8aa3b, v165
  v_exp_f32 v164, v164
  v_exp_f32 v165, v165
  v_max_f32 v162, 0, v162
  v_max_f32 v163, 0, v163
  v_add_f32 v162, v162, v164
  v_add_f32 v163, v163, v165
  v_cvt_pk_bf16_f32 v164, v162, v163
  v_lshlrev_b32 v162, 16, v164
  v_and_b32 v163, 0xffff0000, v164
  v_add_f32 v162, 0x358637bd, v162
  v_add_f32 v163, 0x358637bd, v163
  v_cvt_pk_bf16_f32 v148, v162, v163
  v_lshlrev_b32 v166, 16, v119
  v_and_b32 v167, 0xffff0000, v119
  v_min_f32 v168, 0, v166
  v_min_f32 v169, 0, v167
  v_mul_f32 v168, 0x3fb8aa3b, v168
  v_mul_f32 v169, 0x3fb8aa3b, v169
  v_exp_f32 v168, v168
  v_exp_f32 v169, v169
  v_max_f32 v166, 0, v166
  v_max_f32 v167, 0, v167
  v_add_f32 v166, v166, v168
  v_add_f32 v167, v167, v169
  v_cvt_pk_bf16_f32 v168, v166, v167
  v_lshlrev_b32 v166, 16, v168
  v_and_b32 v167, 0xffff0000, v168
  v_add_f32 v166, 0x358637bd, v166
  v_add_f32 v167, 0x358637bd, v167
  v_cvt_pk_bf16_f32 v149, v166, v167
  v_lshlrev_b32 v162, 16, v120
  v_and_b32 v163, 0xffff0000, v120
  v_min_f32 v164, 0, v162
  v_min_f32 v165, 0, v163
  v_mul_f32 v164, 0x3fb8aa3b, v164
  v_mul_f32 v165, 0x3fb8aa3b, v165
  v_exp_f32 v164, v164
  v_exp_f32 v165, v165
  v_max_f32 v162, 0, v162
  v_max_f32 v163, 0, v163
  v_add_f32 v162, v162, v164
  v_add_f32 v163, v163, v165
  v_cvt_pk_bf16_f32 v164, v162, v163
  v_lshlrev_b32 v162, 16, v164
  v_and_b32 v163, 0xffff0000, v164
  v_add_f32 v162, 0x358637bd, v162
  v_add_f32 v163, 0x358637bd, v163
  v_cvt_pk_bf16_f32 v150, v162, v163
  v_lshlrev_b32 v166, 16, v121
  v_and_b32 v167, 0xffff0000, v121
  v_min_f32 v168, 0, v166
  v_min_f32 v169, 0, v167
  v_mul_f32 v168, 0x3fb8aa3b, v168
  v_mul_f32 v169, 0x3fb8aa3b, v169
  v_exp_f32 v168, v168
  v_exp_f32 v169, v169
  v_max_f32 v166, 0, v166
  v_max_f32 v167, 0, v167
  v_add_f32 v166, v166, v168
  v_add_f32 v167, v167, v169
  v_cvt_pk_bf16_f32 v168, v166, v167
  v_lshlrev_b32 v166, 16, v168
  v_and_b32 v167, 0xffff0000, v168
  v_add_f32 v166, 0x358637bd, v166
  v_add_f32 v167, 0x358637bd, v167
  v_cvt_pk_bf16_f32 v151, v166, v167
  v_lshlrev_b32 v162, 16, v122
  v_and_b32 v163, 0xffff0000, v122
  v_min_f32 v164, 0, v162
  v_min_f32 v165, 0, v163
  v_mul_f32 v164, 0x3fb8aa3b, v164
  v_mul_f32 v165, 0x3fb8aa3b, v165
  v_exp_f32 v164, v164
  v_exp_f32 v165, v165
  v_max_f32 v162, 0, v162
  v_max_f32 v163, 0, v163
  v_add_f32 v162, v162, v164
  v_add_f32 v163, v163, v165
  v_cvt_pk_bf16_f32 v164, v162, v163
  v_lshlrev_b32 v162, 16, v164
  v_and_b32 v163, 0xffff0000, v164
  v_add_f32 v162, 0x358637bd, v162
  v_add_f32 v163, 0x358637bd, v163
  v_cvt_pk_bf16_f32 v152, v162, v163
  v_lshlrev_b32 v166, 16, v123
  v_and_b32 v167, 0xffff0000, v123
  v_min_f32 v168, 0, v166
  v_min_f32 v169, 0, v167
  v_mul_f32 v168, 0x3fb8aa3b, v168
  v_mul_f32 v169, 0x3fb8aa3b, v169
  v_exp_f32 v168, v168
  v_exp_f32 v169, v169
  v_max_f32 v166, 0, v166
  v_max_f32 v167, 0, v167
  v_add_f32 v166, v166, v168
  v_add_f32 v167, v167, v169
  v_cvt_pk_bf16_f32 v168, v166, v167
  v_lshlrev_b32 v166, 16, v168
  v_and_b32 v167, 0xffff0000, v168
  v_add_f32 v166, 0x358637bd, v166
  v_add_f32 v167, 0x358637bd, v167
  v_cvt_pk_bf16_f32 v153, v166, v167
  v_lshlrev_b32 v162, 16, v124
  v_and_b32 v163, 0xffff0000, v124
  v_min_f32 v164, 0, v162
  v_min_f32 v165, 0, v163
  v_mul_f32 v164, 0x3fb8aa3b, v164
  v_mul_f32 v165, 0x3fb8aa3b, v165
  v_exp_f32 v164, v164
  v_exp_f32 v165, v165
  v_max_f32 v162, 0, v162
  v_max_f32 v163, 0, v163
  v_add_f32 v162, v162, v164
  v_add_f32 v163, v163, v165
  v_cvt_pk_bf16_f32 v164, v162, v163
  v_lshlrev_b32 v162, 16, v164
  v_and_b32 v163, 0xffff0000, v164
  v_add_f32 v162, 0x358637bd, v162
  v_add_f32 v163, 0x358637bd, v163
  v_cvt_pk_bf16_f32 v154, v162, v163
  v_lshlrev_b32 v166, 16, v125
  v_and_b32 v167, 0xffff0000, v125
  v_min_f32 v168, 0, v166
  v_min_f32 v169, 0, v167
  v_mul_f32 v168, 0x3fb8aa3b, v168
  v_mul_f32 v169, 0x3fb8aa3b, v169
  v_exp_f32 v168, v168
  v_exp_f32 v169, v169
  v_max_f32 v166, 0, v166
  v_max_f32 v167, 0, v167
  v_add_f32 v166, v166, v168
  v_add_f32 v167, v167, v169
  v_cvt_pk_bf16_f32 v168, v166, v167
  v_lshlrev_b32 v166, 16, v168
  v_and_b32 v167, 0xffff0000, v168
  v_add_f32 v166, 0x358637bd, v166
  v_add_f32 v167, 0x358637bd, v167
  v_cvt_pk_bf16_f32 v155, v166, v167
  v_lshlrev_b32 v162, 16, v126
  v_and_b32 v163, 0xffff0000, v126
  v_min_f32 v164, 0, v162
  v_min_f32 v165, 0, v163
  v_mul_f32 v164, 0x3fb8aa3b, v164
  v_mul_f32 v165, 0x3fb8aa3b, v165
  v_exp_f32 v164, v164
  v_exp_f32 v165, v165
  v_max_f32 v162, 0, v162
  v_max_f32 v163, 0, v163
  v_add_f32 v162, v162, v164
  v_add_f32 v163, v163, v165
  v_cvt_pk_bf16_f32 v164, v162, v163
  v_lshlrev_b32 v162, 16, v164
  v_and_b32 v163, 0xffff0000, v164
  v_add_f32 v162, 0x358637bd, v162
  v_add_f32 v163, 0x358637bd, v163
  v_cvt_pk_bf16_f32 v156, v162, v163
  v_lshlrev_b32 v166, 16, v127
  v_and_b32 v167, 0xffff0000, v127
  v_min_f32 v168, 0, v166
  v_min_f32 v169, 0, v167
  v_mul_f32 v168, 0x3fb8aa3b, v168
  v_mul_f32 v169, 0x3fb8aa3b, v169
  v_exp_f32 v168, v168
  v_exp_f32 v169, v169
  v_max_f32 v166, 0, v166
  v_max_f32 v167, 0, v167
  v_add_f32 v166, v166, v168
  v_add_f32 v167, v167, v169
  v_cvt_pk_bf16_f32 v168, v166, v167
  v_lshlrev_b32 v166, 16, v168
  v_and_b32 v167, 0xffff0000, v168
  v_add_f32 v166, 0x358637bd, v166
  v_add_f32 v167, 0x358637bd, v167
  v_cvt_pk_bf16_f32 v157, v166, v167
  v_lshlrev_b32 v162, 16, v128
  v_and_b32 v163, 0xffff0000, v128
  v_min_f32 v164, 0, v162
  v_min_f32 v165, 0, v163
  v_mul_f32 v164, 0x3fb8aa3b, v164
  v_mul_f32 v165, 0x3fb8aa3b, v165
  v_exp_f32 v164, v164
  v_exp_f32 v165, v165
  v_max_f32 v162, 0, v162
  v_max_f32 v163, 0, v163
  v_add_f32 v162, v162, v164
  v_add_f32 v163, v163, v165
  v_cvt_pk_bf16_f32 v164, v162, v163
  v_lshlrev_b32 v162, 16, v164
  v_and_b32 v163, 0xffff0000, v164
  v_add_f32 v162, 0x358637bd, v162
  v_add_f32 v163, 0x358637bd, v163
  v_cvt_pk_bf16_f32 v158, v162, v163
  v_lshlrev_b32 v166, 16, v129
  v_and_b32 v167, 0xffff0000, v129
  v_min_f32 v168, 0, v166
  v_min_f32 v169, 0, v167
  v_mul_f32 v168, 0x3fb8aa3b, v168
  v_mul_f32 v169, 0x3fb8aa3b, v169
  v_exp_f32 v168, v168
  v_exp_f32 v169, v169
  v_max_f32 v166, 0, v166
  v_max_f32 v167, 0, v167
  v_add_f32 v166, v166, v168
  v_add_f32 v167, v167, v169
  v_cvt_pk_bf16_f32 v168, v166, v167
  v_lshlrev_b32 v166, 16, v168
  v_and_b32 v167, 0xffff0000, v168
  v_add_f32 v166, 0x358637bd, v166
  v_add_f32 v167, 0x358637bd, v167
  v_cvt_pk_bf16_f32 v159, v166, v167
  v_lshlrev_b32 v162, 16, v130
  v_and_b32 v163, 0xffff0000, v130
  v_min_f32 v164, 0, v162
  v_min_f32 v165, 0, v163
  v_mul_f32 v164, 0x3fb8aa3b, v164
  v_mul_f32 v165, 0x3fb8aa3b, v165
  v_exp_f32 v164, v164
  v_exp_f32 v165, v165
  v_max_f32 v162, 0, v162
  v_max_f32 v163, 0, v163
  v_add_f32 v162, v162, v164
  v_add_f32 v163, v163, v165
  v_cvt_pk_bf16_f32 v164, v162, v163
  v_lshlrev_b32 v162, 16, v164
  v_and_b32 v163, 0xffff0000, v164
  v_add_f32 v162, 0x358637bd, v162
  v_add_f32 v163, 0x358637bd, v163
  v_cvt_pk_bf16_f32 v160, v162, v163
  v_lshlrev_b32 v166, 16, v131
  v_and_b32 v167, 0xffff0000, v131
  v_min_f32 v168, 0, v166
  v_min_f32 v169, 0, v167
  v_mul_f32 v168, 0x3fb8aa3b, v168
  v_mul_f32 v169, 0x3fb8aa3b, v169
  v_exp_f32 v168, v168
  v_exp_f32 v169, v169
  v_max_f32 v166, 0, v166
  v_max_f32 v167, 0, v167
  v_add_f32 v166, v166, v168
  v_add_f32 v167, v167, v169
  v_cvt_pk_bf16_f32 v168, v166, v167
  v_lshlrev_b32 v166, 16, v168
  v_and_b32 v167, 0xffff0000, v168
  v_add_f32 v166, 0x358637bd, v166
  v_add_f32 v167, 0x358637bd, v167
  v_cvt_pk_bf16_f32 v161, v166, v167
  s_lshl_b32 s40, s27, 2
  s_add_u32 s40, s40, s25
  s_lshl_b32 s40, s40, 3
  s_add_u32 s40, s40, s30
  s_mul_i32 s40, s40, 5120
  s_add_u32 s40, s40, 2048
  v_lshlrev_b32 v162, 4, v192
  v_mov_b32 v186, v150
  v_mov_b32 v187, v151
  v_mov_b32 v188, 0
  v_mov_b32 v189, 0
  buffer_store_dwordx4 v[142:145], v162, s[16:19], s40 offen offset:0 sc0 sc1
  buffer_store_dwordx4 v[146:149], v162, s[16:19], s40 offen offset:1024 sc0 sc1
  buffer_store_dwordx4 v[186:189], v162, s[16:19], s40 offen offset:2048 sc0 sc1
  s_barrier
  v_and_b32 v162, 31, v192
  v_lshrrev_b32 v163, 5, v192
  s_lshl_b32 s40, s25, 5
  v_add_u32 v162, s40, v162
  v_mul_u32_u24 v162, 328, v162
  v_lshl_add_u32 v190, v163, 3, v162
  v_mul_u32_u24 v163, 12, v163
  v_add_u32 v191, v163, v162
  ds_write_b64 v190, v[152:153] offset:64
  ds_write_b64 v190, v[154:155] offset:80
  ds_write_b64 v190, v[156:157] offset:96
  ds_write_b64 v190, v[158:159] offset:112
  ds_write_b64 v190, v[160:161] offset:128
  ds_write_b32 v191, v132 offset:212
  ds_write_b32 v191, v133 offset:216
  ds_write_b32 v190, v134 offset:232
  ds_write_b32 v190, v135 offset:236
  ds_write_b32 v190, v136 offset:248
  ds_write_b32 v191, v137 offset:252
  ds_write_b32 v190, v138 offset:268
  ds_write_b32 v190, v139 offset:272
  ds_write_b32 v190, v140 offset:284
  ds_write_b32 v190, v141 offset:288
  s_waitcnt lgkmcnt(0)
  s_barrier
  s_load_dwordx2 s[20:21], s[0:1], 16
  s_load_dwordx2 s[22:23], s[0:1], 48
  s_load_dwordx2 s[44:45], s[0:1], 56
  v_and_b32 v3, 15, v192
  v_lshrrev_b32 v4, 4, v192
  v_lshrrev_b32 v0, 1, v4
  v_mul_u32_u24 v0, 18, v0
  v_and_b32 v84, 1, v4
  v_lshl_add_u32 v0, v84, 2, v0
  v_mul_u32_u24 v0, 1152, v0
  v_mul_u32_u24 v1, 82944, v4
  s_lshl_b32 s46, s27, 3
  s_add_u32 s46, s46, s30
  s_lshl_b32 s46, s46, 2
  s_add_u32 s46, s46, s25
  s_waitcnt lgkmcnt(0)
  v_mov_b32 v85, 0x7fff0000
  s_add_u32 s40, s46, 0
  s_min_u32 s47, s40, 1439
  s_mul_i32 s41, s47, 52429
  s_lshr_b32 s41, s41, 18
  s_mul_i32 s42, s41, 5
  s_sub_u32 s42, s47, s42
  s_mul_i32 s43, s41, 58255
  s_lshr_b32 s43, s43, 20
  s_mul_i32 s48, s43, 18
  s_sub_u32 s48, s41, s48
  s_and_b32 s49, s43, 7
  s_lshr_b32 s50, s43, 3
  s_cmp_eq_u32 s50, 0
  s_cselect_b32 s52, s20, s22
  s_cselect_b32 s53, s21, s23
  s_and_b32 s53, s53, 0xffff
  s_mov_b32 s54, 663552
  s_mov_b32 s55, 0x20000
  s_mul_i32 s49, s49, 72
  s_lshl_b32 s42, s42, 4
  s_add_u32 s49, s49, s42
  v_add_u32 v86, s42, v3
  v_add_u32 v87, s49, v3
  v_lshlrev_b32 v87, 1, v87
  v_cmp_gt_u32 vcc, 72, v86
  s_nop 1
  v_cndmask_b32 v87, v85, v87, vcc
  s_cmp_lt_u32 s48, 16
  s_cselect_b64 vcc, -1, 0
  s_cselect_b32 s51, 1, 0
  v_cndmask_b32 v2, v1, v0, vcc
  v_add_u32 v2, v2, v87
  s_mul_i32 s41, s48, 41472
  s_sub_u32 s42, s48, 16
  s_mul_i32 s42, s42, 331776
  s_add_u32 s42, s42, 18432
  s_cmp_lt_u32 s48, 16
  s_cselect_b32 s41, s41, s42
  s_mul_i32 s42, s51, 0
  s_add_u32 s42, s42, 0
  s_add_u32 s42, s42, s41
  buffer_load_ushort v8, v2, s[52:55], s42 offen
  s_mul_i32 s42, s51, 0
  s_add_u32 s42, s42, 1152
  s_add_u32 s42, s42, s41
  buffer_load_ushort v9, v2, s[52:55], s42 offen
  s_mul_i32 s42, s51, -18432
  s_add_u32 s42, s42, 20736
  s_add_u32 s42, s42, s41
  buffer_load_ushort v10, v2, s[52:55], s42 offen
  s_mul_i32 s42, s51, -18432
  s_add_u32 s42, s42, 21888
  s_add_u32 s42, s42, s41
  buffer_load_ushort v11, v2, s[52:55], s42 offen
  s_mul_i32 s42, s51, -32256
  s_add_u32 s42, s42, 41472
  s_add_u32 s42, s42, s41
  buffer_load_ushort v12, v2, s[52:55], s42 offen
  s_mul_i32 s42, s51, -32256
  s_add_u32 s42, s42, 42624
  s_add_u32 s42, s42, s41
  buffer_load_ushort v13, v2, s[52:55], s42 offen
  s_mul_i32 s42, s51, -50688
  s_add_u32 s42, s42, 62208
  s_add_u32 s42, s42, s41
  buffer_load_ushort v14, v2, s[52:55], s42 offen
  s_mul_i32 s42, s51, -50688
  s_add_u32 s42, s42, 63360
  s_add_u32 s42, s42, s41
  buffer_load_ushort v15, v2, s[52:55], s42 offen
  s_add_u32 s40, s46, 512
  s_min_u32 s47, s40, 1439
  s_mul_i32 s41, s47, 52429
  s_lshr_b32 s41, s41, 18
  s_mul_i32 s42, s41, 5
  s_sub_u32 s42, s47, s42
  s_mul_i32 s43, s41, 58255
  s_lshr_b32 s43, s43, 20
  s_mul_i32 s48, s43, 18
  s_sub_u32 s48, s41, s48
  s_and_b32 s49, s43, 7
  s_lshr_b32 s50, s43, 3
  s_cmp_eq_u32 s50, 0
  s_cselect_b32 s52, s20, s22
  s_cselect_b32 s53, s21, s23
  s_and_b32 s53, s53, 0xffff
  s_mov_b32 s54, 663552
  s_mov_b32 s55, 0x20000
  s_mul_i32 s49, s49, 72
  s_lshl_b32 s42, s42, 4
  s_add_u32 s49, s49, s42
  v_add_u32 v86, s42, v3
  v_add_u32 v87, s49, v3
  v_lshlrev_b32 v87, 1, v87
  v_cmp_gt_u32 vcc, 72, v86
  s_nop 1
  v_cndmask_b32 v87, v85, v87, vcc
  s_cmp_lt_u32 s48, 16
  s_cselect_b64 vcc, -1, 0
  s_cselect_b32 s51, 1, 0
  v_cndmask_b32 v2, v1, v0, vcc
  v_add_u32 v2, v2, v87
  s_mul_i32 s41, s48, 41472
  s_sub_u32 s42, s48, 16
  s_mul_i32 s42, s42, 331776
  s_add_u32 s42, s42, 18432
  s_cmp_lt_u32 s48, 16
  s_cselect_b32 s41, s41, s42
  s_mul_i32 s42, s51, 0
  s_add_u32 s42, s42, 0
  s_add_u32 s42, s42, s41
  buffer_load_ushort v16, v2, s[52:55], s42 offen
  s_mul_i32 s42, s51, 0
  s_add_u32 s42, s42, 1152
  s_add_u32 s42, s42, s41
  buffer_load_ushort v17, v2, s[52:55], s42 offen
  s_mul_i32 s42, s51, -18432
  s_add_u32 s42, s42, 20736
  s_add_u32 s42, s42, s41
  buffer_load_ushort v18, v2, s[52:55], s42 offen
  s_mul_i32 s42, s51, -18432
  s_add_u32 s42, s42, 21888
  s_add_u32 s42, s42, s41
  buffer_load_ushort v19, v2, s[52:55], s42 offen
  s_mul_i32 s42, s51, -32256
  s_add_u32 s42, s42, 41472
  s_add_u32 s42, s42, s41
  buffer_load_ushort v20, v2, s[52:55], s42 offen
  s_mul_i32 s42, s51, -32256
  s_add_u32 s42, s42, 42624
  s_add_u32 s42, s42, s41
  buffer_load_ushort v21, v2, s[52:55], s42 offen
  s_mul_i32 s42, s51, -50688
  s_add_u32 s42, s42, 62208
  s_add_u32 s42, s42, s41
  buffer_load_ushort v22, v2, s[52:55], s42 offen
  s_mul_i32 s42, s51, -50688
  s_add_u32 s42, s42, 63360
  s_add_u32 s42, s42, s41
  buffer_load_ushort v23, v2, s[52:55], s42 offen
  s_add_u32 s40, s46, 1024
  s_min_u32 s47, s40, 1439
  s_mul_i32 s41, s47, 52429
  s_lshr_b32 s41, s41, 18
  s_mul_i32 s42, s41, 5
  s_sub_u32 s42, s47, s42
  s_mul_i32 s43, s41, 58255
  s_lshr_b32 s43, s43, 20
  s_mul_i32 s48, s43, 18
  s_sub_u32 s48, s41, s48
  s_and_b32 s49, s43, 7
  s_lshr_b32 s50, s43, 3
  s_cmp_eq_u32 s50, 0
  s_cselect_b32 s52, s20, s22
  s_cselect_b32 s53, s21, s23
  s_and_b32 s53, s53, 0xffff
  s_mov_b32 s54, 663552
  s_mov_b32 s55, 0x20000
  s_mul_i32 s49, s49, 72
  s_lshl_b32 s42, s42, 4
  s_add_u32 s49, s49, s42
  v_add_u32 v86, s42, v3
  v_add_u32 v87, s49, v3
  v_lshlrev_b32 v87, 1, v87
  v_cmp_gt_u32 vcc, 72, v86
  s_nop 1
  v_cndmask_b32 v87, v85, v87, vcc
  s_cmp_lt_u32 s48, 16
  s_cselect_b64 vcc, -1, 0
  s_cselect_b32 s51, 1, 0
  v_cndmask_b32 v2, v1, v0, vcc
  v_add_u32 v2, v2, v87
  s_mul_i32 s41, s48, 41472
  s_sub_u32 s42, s48, 16
  s_mul_i32 s42, s42, 331776
  s_add_u32 s42, s42, 18432
  s_cmp_lt_u32 s48, 16
  s_cselect_b32 s41, s41, s42
  s_mul_i32 s42, s51, 0
  s_add_u32 s42, s42, 0
  s_add_u32 s42, s42, s41
  buffer_load_ushort v24, v2, s[52:55], s42 offen
  s_mul_i32 s42, s51, 0
  s_add_u32 s42, s42, 1152
  s_add_u32 s42, s42, s41
  buffer_load_ushort v25, v2, s[52:55], s42 offen
  s_mul_i32 s42, s51, -18432
  s_add_u32 s42, s42, 20736
  s_add_u32 s42, s42, s41
  buffer_load_ushort v26, v2, s[52:55], s42 offen
  s_mul_i32 s42, s51, -18432
  s_add_u32 s42, s42, 21888
  s_add_u32 s42, s42, s41
  buffer_load_ushort v27, v2, s[52:55], s42 offen
  s_mul_i32 s42, s51, -32256
  s_add_u32 s42, s42, 41472
  s_add_u32 s42, s42, s41
  buffer_load_ushort v28, v2, s[52:55], s42 offen
  s_mul_i32 s42, s51, -32256
  s_add_u32 s42, s42, 42624
  s_add_u32 s42, s42, s41
  buffer_load_ushort v29, v2, s[52:55], s42 offen
  s_mul_i32 s42, s51, -50688
  s_add_u32 s42, s42, 62208
  s_add_u32 s42, s42, s41
  buffer_load_ushort v30, v2, s[52:55], s42 offen
  s_mul_i32 s42, s51, -50688
  s_add_u32 s42, s42, 63360
  s_add_u32 s42, s42, s41
  buffer_load_ushort v31, v2, s[52:55], s42 offen
  s_mov_b32 s52, s44
  s_and_b32 s53, s45, 0xffff
  s_mov_b32 s54, 0x480
  s_mov_b32 s55, 0x20000
  v_lshlrev_b32 v88, 1, v192
  buffer_load_ushort v32, v88, s[52:55], 0 offen offset:0
  buffer_load_ushort v33, v88, s[52:55], 0 offen offset:128
  buffer_load_ushort v34, v88, s[52:55], 0 offen offset:256
  buffer_load_ushort v35, v88, s[52:55], 0 offen offset:384
  buffer_load_ushort v36, v88, s[52:55], 0 offen offset:512
  buffer_load_ushort v37, v88, s[52:55], 0 offen offset:640
  buffer_load_ushort v38, v88, s[52:55], 0 offen offset:768
  buffer_load_ushort v39, v88, s[52:55], 0 offen offset:896
  buffer_load_ushort v40, v88, s[52:55], 0 offen offset:1024
  s_lshl_b32 s40, s46, 2
  s_add_u32 s41, s40, 0
  s_mul_i32 s42, s41, 1152
  buffer_load_ushort v44, v88, s[12:15], s42 offen offset:0
  buffer_load_ushort v45, v88, s[12:15], s42 offen offset:128
  buffer_load_ushort v46, v88, s[12:15], s42 offen offset:256
  buffer_load_ushort v47, v88, s[12:15], s42 offen offset:384
  buffer_load_ushort v48, v88, s[12:15], s42 offen offset:512
  buffer_load_ushort v49, v88, s[12:15], s42 offen offset:640
  buffer_load_ushort v50, v88, s[12:15], s42 offen offset:768
  buffer_load_ushort v51, v88, s[12:15], s42 offen offset:896
  buffer_load_ushort v52, v88, s[12:15], s42 offen offset:1024
  s_add_u32 s41, s40, 1
  s_mul_i32 s42, s41, 1152
  buffer_load_ushort v53, v88, s[12:15], s42 offen offset:0
  buffer_load_ushort v54, v88, s[12:15], s42 offen offset:128
  buffer_load_ushort v55, v88, s[12:15], s42 offen offset:256
  buffer_load_ushort v56, v88, s[12:15], s42 offen offset:384
  buffer_load_ushort v57, v88, s[12:15], s42 offen offset:512
  buffer_load_ushort v58, v88, s[12:15], s42 offen offset:640
  buffer_load_ushort v59, v88, s[12:15], s42 offen offset:768
  buffer_load_ushort v60, v88, s[12:15], s42 offen offset:896
  buffer_load_ushort v61, v88, s[12:15], s42 offen offset:1024
  s_add_u32 s41, s40, 2
  s_mul_i32 s42, s41, 1152
  buffer_load_ushort v62, v88, s[12:15], s42 offen offset:0
  buffer_load_ushort v63, v88, s[12:15], s42 offen offset:128
  buffer_load_ushort v64, v88, s[12:15], s42 offen offset:256
  buffer_load_ushort v65, v88, s[12:15], s42 offen offset:384
  buffer_load_ushort v66, v88, s[12:15], s42 offen offset:512
  buffer_load_ushort v67, v88, s[12:15], s42 offen offset:640
  buffer_load_ushort v68, v88, s[12:15], s42 offen offset:768
  buffer_load_ushort v69, v88, s[12:15], s42 offen offset:896
  s_waitcnt vmcnt(60)
  buffer_load_ushort v70, v88, s[12:15], s42 offen offset:1024
  s_add_u32 s41, s40, 3
  s_mul_i32 s42, s41, 1152
  buffer_load_ushort v71, v88, s[12:15], s42 offen offset:0
  s_waitcnt vmcnt(60)
  buffer_load_ushort v72, v88, s[12:15], s42 offen offset:128
  buffer_load_ushort v73, v88, s[12:15], s42 offen offset:256
  s_waitcnt vmcnt(60)
  buffer_load_ushort v74, v88, s[12:15], s42 offen offset:384
  buffer_load_ushort v75, v88, s[12:15], s42 offen offset:512
  s_waitcnt vmcnt(60)
  buffer_load_ushort v76, v88, s[12:15], s42 offen offset:640
  buffer_load_ushort v77, v88, s[12:15], s42 offen offset:768
  s_waitcnt vmcnt(60)
  buffer_load_ushort v78, v88, s[12:15], s42 offen offset:896
  buffer_load_ushort v79, v88, s[12:15], s42 offen offset:1024
  v_lshlrev_b32 v89, 4, v192
  v_lshl_or_b32 v92, v9, 16, v8
  v_lshl_or_b32 v93, v11, 16, v10
  v_lshl_or_b32 v94, v13, 16, v12
  s_waitcnt vmcnt(61)
  v_lshl_or_b32 v95, v15, 16, v14
  s_add_u32 s41, s46, 0
  s_lshl_b32 s42, s41, 10
  s_add_u32 s42, s42, 16777216
  buffer_store_dwordx4 v[92:95], v89, s[16:19], s42 offen sc0 sc1
  s_waitcnt vmcnt(60)
  s_nop 0
  v_lshl_or_b32 v92, v17, 16, v16
  s_waitcnt vmcnt(58)
  v_lshl_or_b32 v93, v19, 16, v18
  s_waitcnt vmcnt(56)
  v_lshl_or_b32 v94, v21, 16, v20
  s_waitcnt vmcnt(54)
  v_lshl_or_b32 v95, v23, 16, v22
  s_add_u32 s41, s46, 512
  s_lshl_b32 s42, s41, 10
  s_add_u32 s42, s42, 16777216
  buffer_store_dwordx4 v[92:95], v89, s[16:19], s42 offen sc0 sc1
  s_waitcnt vmcnt(53)
  s_nop 0
  v_lshl_or_b32 v92, v25, 16, v24
  s_waitcnt vmcnt(51)
  v_lshl_or_b32 v93, v27, 16, v26
  s_waitcnt vmcnt(49)
  v_lshl_or_b32 v94, v29, 16, v28
  s_waitcnt vmcnt(47)
  v_lshl_or_b32 v95, v31, 16, v30
  s_add_u32 s41, s46, 1024
  s_lshl_b32 s42, s41, 10
  s_add_u32 s42, s42, 16777216
  s_cmp_lt_u32 s41, 1440
  s_cselect_b64 vcc, -1, 0
  v_cndmask_b32 v90, v85, v89, vcc
  buffer_store_dwordx4 v[92:95], v90, s[16:19], s42 offen sc0 sc1
  s_waitcnt vmcnt(47)
  v_lshlrev_b32 v32, 16, v32
  s_waitcnt vmcnt(46)
  v_lshlrev_b32 v33, 16, v33
  s_waitcnt vmcnt(45)
  v_lshlrev_b32 v34, 16, v34
  s_waitcnt vmcnt(44)
  v_lshlrev_b32 v35, 16, v35
  s_waitcnt vmcnt(43)
  v_lshlrev_b32 v36, 16, v36
  s_waitcnt vmcnt(42)
  v_lshlrev_b32 v37, 16, v37
  s_waitcnt vmcnt(41)
  v_lshlrev_b32 v38, 16, v38
  s_waitcnt vmcnt(40)
  v_lshlrev_b32 v39, 16, v39
  s_waitcnt vmcnt(39)
  v_lshlrev_b32 v40, 16, v40
  s_waitcnt vmcnt(38)
  v_lshlrev_b32 v44, 16, v44
  v_mul_f32 v44, v44, v32
  s_waitcnt vmcnt(37)
  v_lshlrev_b32 v45, 16, v45
  v_mul_f32 v45, v45, v33
  s_waitcnt vmcnt(36)
  v_lshlrev_b32 v46, 16, v46
  v_mul_f32 v46, v46, v34
  s_waitcnt vmcnt(35)
  v_lshlrev_b32 v47, 16, v47
  v_mul_f32 v47, v47, v35
  s_waitcnt vmcnt(34)
  v_lshlrev_b32 v48, 16, v48
  v_mul_f32 v48, v48, v36
  s_waitcnt vmcnt(33)
  v_lshlrev_b32 v49, 16, v49
  v_mul_f32 v49, v49, v37
  s_waitcnt vmcnt(32)
  v_lshlrev_b32 v50, 16, v50
  v_mul_f32 v50, v50, v38
  s_waitcnt vmcnt(31)
  v_lshlrev_b32 v51, 16, v51
  v_mul_f32 v51, v51, v39
  s_waitcnt vmcnt(30)
  v_lshlrev_b32 v52, 16, v52
  v_mul_f32 v52, v52, v40
  v_cvt_pk_bf16_f32 v44, v44, v45
  v_cvt_pk_bf16_f32 v46, v46, v47
  v_cvt_pk_bf16_f32 v48, v48, v49
  v_cvt_pk_bf16_f32 v50, v50, v51
  v_cvt_pk_bf16_f32 v52, v52, v52
  v_and_b32 v96, 0xffff0000, v52
  v_lshlrev_b32 v45, 16, v44
  v_and_b32 v44, 0xffff0000, v44
  v_add_f32 v96, v96, v45
  v_add_f32 v96, v96, v44
  v_lshlrev_b32 v47, 16, v46
  v_and_b32 v46, 0xffff0000, v46
  v_add_f32 v96, v96, v47
  v_add_f32 v96, v96, v46
  v_lshlrev_b32 v49, 16, v48
  v_and_b32 v48, 0xffff0000, v48
  v_add_f32 v96, v96, v49
  v_add_f32 v96, v96, v48
  v_lshlrev_b32 v51, 16, v50
  v_and_b32 v50, 0xffff0000, v50
  v_add_f32 v96, v96, v51
  v_add_f32 v96, v96, v50
  s_waitcnt vmcnt(29)
  v_lshlrev_b32 v53, 16, v53
  v_mul_f32 v53, v53, v32
  s_waitcnt vmcnt(28)
  v_lshlrev_b32 v54, 16, v54
  v_mul_f32 v54, v54, v33
  s_waitcnt vmcnt(27)
  v_lshlrev_b32 v55, 16, v55
  v_mul_f32 v55, v55, v34
  s_waitcnt vmcnt(26)
  v_lshlrev_b32 v56, 16, v56
  v_mul_f32 v56, v56, v35
  s_waitcnt vmcnt(25)
  v_lshlrev_b32 v57, 16, v57
  v_mul_f32 v57, v57, v36
  s_waitcnt vmcnt(24)
  v_lshlrev_b32 v58, 16, v58
  v_mul_f32 v58, v58, v37
  s_waitcnt vmcnt(23)
  v_lshlrev_b32 v59, 16, v59
  v_mul_f32 v59, v59, v38
  s_waitcnt vmcnt(22)
  v_lshlrev_b32 v60, 16, v60
  v_mul_f32 v60, v60, v39
  s_waitcnt vmcnt(21)
  v_lshlrev_b32 v61, 16, v61
  v_mul_f32 v61, v61, v40
  v_cvt_pk_bf16_f32 v53, v53, v54
  v_cvt_pk_bf16_f32 v55, v55, v56
  v_cvt_pk_bf16_f32 v57, v57, v58
  v_cvt_pk_bf16_f32 v59, v59, v60
  v_cvt_pk_bf16_f32 v61, v61, v61
  v_and_b32 v97, 0xffff0000, v61
  v_lshlrev_b32 v54, 16, v53
  v_and_b32 v53, 0xffff0000, v53
  v_add_f32 v97, v97, v54
  v_add_f32 v97, v97, v53
  v_lshlrev_b32 v56, 16, v55
  v_and_b32 v55, 0xffff0000, v55
  v_add_f32 v97, v97, v56
  v_add_f32 v97, v97, v55
  v_lshlrev_b32 v58, 16, v57
  v_and_b32 v57, 0xffff0000, v57
  v_add_f32 v97, v97, v58
  v_add_f32 v97, v97, v57
  v_lshlrev_b32 v60, 16, v59
  v_and_b32 v59, 0xffff0000, v59
  v_add_f32 v97, v97, v60
  v_add_f32 v97, v97, v59
  s_waitcnt vmcnt(20)
  v_lshlrev_b32 v62, 16, v62
  v_mul_f32 v62, v62, v32
  s_waitcnt vmcnt(19)
  v_lshlrev_b32 v63, 16, v63
  v_mul_f32 v63, v63, v33
  s_waitcnt vmcnt(18)
  v_lshlrev_b32 v64, 16, v64
  v_mul_f32 v64, v64, v34
  s_waitcnt vmcnt(17)
  v_lshlrev_b32 v65, 16, v65
  v_mul_f32 v65, v65, v35
  s_waitcnt vmcnt(16)
  v_lshlrev_b32 v66, 16, v66
  v_mul_f32 v66, v66, v36
  s_waitcnt vmcnt(15)
  v_lshlrev_b32 v67, 16, v67
  v_mul_f32 v67, v67, v37
  s_waitcnt vmcnt(14)
  v_lshlrev_b32 v68, 16, v68
  v_mul_f32 v68, v68, v38
  s_waitcnt vmcnt(13)
  v_lshlrev_b32 v69, 16, v69
  v_mul_f32 v69, v69, v39
  s_waitcnt vmcnt(12)
  v_lshlrev_b32 v70, 16, v70
  v_mul_f32 v70, v70, v40
  v_cvt_pk_bf16_f32 v62, v62, v63
  v_cvt_pk_bf16_f32 v64, v64, v65
  v_cvt_pk_bf16_f32 v66, v66, v67
  v_cvt_pk_bf16_f32 v68, v68, v69
  v_cvt_pk_bf16_f32 v70, v70, v70
  v_and_b32 v98, 0xffff0000, v70
  v_lshlrev_b32 v63, 16, v62
  v_and_b32 v62, 0xffff0000, v62
  v_add_f32 v98, v98, v63
  v_add_f32 v98, v98, v62
  v_lshlrev_b32 v65, 16, v64
  v_and_b32 v64, 0xffff0000, v64
  v_add_f32 v98, v98, v65
  v_add_f32 v98, v98, v64
  v_lshlrev_b32 v67, 16, v66
  v_and_b32 v66, 0xffff0000, v66
  v_add_f32 v98, v98, v67
  v_add_f32 v98, v98, v66
  v_lshlrev_b32 v69, 16, v68
  v_and_b32 v68, 0xffff0000, v68
  v_add_f32 v98, v98, v69
  v_add_f32 v98, v98, v68
  s_waitcnt vmcnt(11)
  v_lshlrev_b32 v71, 16, v71
  v_mul_f32 v71, v71, v32
  s_waitcnt vmcnt(10)
  v_lshlrev_b32 v72, 16, v72
  v_mul_f32 v72, v72, v33
  s_waitcnt vmcnt(9)
  v_lshlrev_b32 v73, 16, v73
  v_mul_f32 v73, v73, v34
  s_waitcnt vmcnt(8)
  v_lshlrev_b32 v74, 16, v74
  v_mul_f32 v74, v74, v35
  s_waitcnt vmcnt(7)
  v_lshlrev_b32 v75, 16, v75
  v_mul_f32 v75, v75, v36
  s_waitcnt vmcnt(6)
  v_lshlrev_b32 v76, 16, v76
  v_mul_f32 v76, v76, v37
  s_waitcnt vmcnt(5)
  v_lshlrev_b32 v77, 16, v77
  v_mul_f32 v77, v77, v38
  s_waitcnt vmcnt(4)
  v_lshlrev_b32 v78, 16, v78
  v_mul_f32 v78, v78, v39
  s_waitcnt vmcnt(3)
  v_lshlrev_b32 v79, 16, v79
  v_mul_f32 v79, v79, v40
  v_cvt_pk_bf16_f32 v71, v71, v72
  v_cvt_pk_bf16_f32 v73, v73, v74
  v_cvt_pk_bf16_f32 v75, v75, v76
  v_cvt_pk_bf16_f32 v77, v77, v78
  v_cvt_pk_bf16_f32 v79, v79, v79
  v_and_b32 v99, 0xffff0000, v79
  v_lshlrev_b32 v72, 16, v71
  v_and_b32 v71, 0xffff0000, v71
  v_add_f32 v99, v99, v72
  v_add_f32 v99, v99, v71
  v_lshlrev_b32 v74, 16, v73
  v_and_b32 v73, 0xffff0000, v73
  v_add_f32 v99, v99, v74
  v_add_f32 v99, v99, v73
  v_lshlrev_b32 v76, 16, v75
  v_and_b32 v75, 0xffff0000, v75
  v_add_f32 v99, v99, v76
  v_add_f32 v99, v99, v75
  v_lshlrev_b32 v78, 16, v77
  v_and_b32 v77, 0xffff0000, v77
  v_add_f32 v99, v99, v78
  v_add_f32 v99, v99, v77
  v_add_f32_dpp v96, v96, v96 row_shr:1 row_mask:0xf bank_mask:0xf bound_ctrl:0
  s_nop 1
  v_add_f32_dpp v96, v96, v96 row_shr:2 row_mask:0xf bank_mask:0xf bound_ctrl:0
  s_nop 1
  v_add_f32_dpp v96, v96, v96 row_shr:4 row_mask:0xf bank_mask:0xf bound_ctrl:0
  s_nop 1
  v_add_f32_dpp v96, v96, v96 row_shr:8 row_mask:0xf bank_mask:0xf bound_ctrl:0
  s_nop 1
  v_add_f32_dpp v96, v96, v96 row_bcast:15 row_mask:0xa bank_mask:0xf
  s_nop 1
  v_add_f32_dpp v96, v96, v96 row_bcast:31 row_mask:0xc bank_mask:0xf
  v_add_f32_dpp v97, v97, v97 row_shr:1 row_mask:0xf bank_mask:0xf bound_ctrl:0
  s_nop 1
  v_add_f32_dpp v97, v97, v97 row_shr:2 row_mask:0xf bank_mask:0xf bound_ctrl:0
  s_nop 1
  v_add_f32_dpp v97, v97, v97 row_shr:4 row_mask:0xf bank_mask:0xf bound_ctrl:0
  s_nop 1
  v_add_f32_dpp v97, v97, v97 row_shr:8 row_mask:0xf bank_mask:0xf bound_ctrl:0
  s_nop 1
  v_add_f32_dpp v97, v97, v97 row_bcast:15 row_mask:0xa bank_mask:0xf
  s_nop 1
  v_add_f32_dpp v97, v97, v97 row_bcast:31 row_mask:0xc bank_mask:0xf
  v_add_f32_dpp v98, v98, v98 row_shr:1 row_mask:0xf bank_mask:0xf bound_ctrl:0
  s_nop 1
  v_add_f32_dpp v98, v98, v98 row_shr:2 row_mask:0xf bank_mask:0xf bound_ctrl:0
  s_nop 1
  v_add_f32_dpp v98, v98, v98 row_shr:4 row_mask:0xf bank_mask:0xf bound_ctrl:0
  s_nop 1
  v_add_f32_dpp v98, v98, v98 row_shr:8 row_mask:0xf bank_mask:0xf bound_ctrl:0
  s_nop 1
  v_add_f32_dpp v98, v98, v98 row_bcast:15 row_mask:0xa bank_mask:0xf
  s_nop 1
  v_add_f32_dpp v98, v98, v98 row_bcast:31 row_mask:0xc bank_mask:0xf
  v_add_f32_dpp v99, v99, v99 row_shr:1 row_mask:0xf bank_mask:0xf bound_ctrl:0
  s_nop 1
  v_add_f32_dpp v99, v99, v99 row_shr:2 row_mask:0xf bank_mask:0xf bound_ctrl:0
  s_nop 1
  v_add_f32_dpp v99, v99, v99 row_shr:4 row_mask:0xf bank_mask:0xf bound_ctrl:0
  s_nop 1
  v_add_f32_dpp v99, v99, v99 row_shr:8 row_mask:0xf bank_mask:0xf bound_ctrl:0
  s_nop 1
  v_add_f32_dpp v99, v99, v99 row_bcast:15 row_mask:0xa bank_mask:0xf
  s_nop 1
  v_add_f32_dpp v99, v99, v99 row_bcast:31 row_mask:0xc bank_mask:0xf
  v_cvt_pk_bf16_f32 v96, v96, v96
  v_lshlrev_b32 v96, 16, v96
  v_mul_f32 v96, 0xbfb8aa3b, v96
  v_exp_f32 v96, v96
  s_nop 0
  v_add_f32 v96, 1.0, v96
  v_rcp_f32 v96, v96
  s_nop 0
  v_cvt_pk_bf16_f32 v96, v96, v96
  v_lshlrev_b32 v96, 16, v96
  v_cvt_pk_bf16_f32 v97, v97, v97
  v_lshlrev_b32 v97, 16, v97
  v_mul_f32 v97, 0xbfb8aa3b, v97
  v_exp_f32 v97, v97
  s_nop 0
  v_add_f32 v97, 1.0, v97
  v_rcp_f32 v97, v97
  s_nop 0
  v_cvt_pk_bf16_f32 v97, v97, v97
  v_lshlrev_b32 v97, 16, v97
  v_cvt_pk_bf16_f32 v98, v98, v98
  v_lshlrev_b32 v98, 16, v98
  v_mul_f32 v98, 0xbfb8aa3b, v98
  v_exp_f32 v98, v98
  s_nop 0
  v_add_f32 v98, 1.0, v98
  v_rcp_f32 v98, v98
  s_nop 0
  v_cvt_pk_bf16_f32 v98, v98, v98
  v_lshlrev_b32 v98, 16, v98
  v_cvt_pk_bf16_f32 v99, v99, v99
  v_lshlrev_b32 v99, 16, v99
  v_mul_f32 v99, 0xbfb8aa3b, v99
  v_exp_f32 v99, v99
  s_nop 0
  v_add_f32 v99, 1.0, v99
  v_rcp_f32 v99, v99
  s_nop 0
  v_cvt_pk_bf16_f32 v99, v99, v99
  v_lshlrev_b32 v99, 16, v99
  v_mov_b32 v86, 0
  v_cmp_eq_u32 vcc, 63, v192
  s_nop 1
  v_cndmask_b32 v86, v85, v86, vcc
  s_lshl_b32 s42, s40, 2
  s_add_u32 s42, s42, 18251776
  buffer_store_dwordx4 v[96:99], v86, s[16:19], s42 offen sc0 sc1
  s_endpgm
k1_epb1:
  s_waitcnt vmcnt(0)
  s_nop 15
  s_nop 7
  v_cvt_pk_bf16_f32 v112, v16, v17
  v_cvt_pk_bf16_f32 v113, v18, v19
  v_cvt_pk_bf16_f32 v114, v20, v21
  v_cvt_pk_bf16_f32 v115, v22, v23
  v_cvt_pk_bf16_f32 v116, v24, v25
  v_cvt_pk_bf16_f32 v117, v26, v27
  v_cvt_pk_bf16_f32 v118, v28, v29
  v_cvt_pk_bf16_f32 v119, v30, v31
  v_cvt_pk_bf16_f32 v120, v32, v33
  v_cvt_pk_bf16_f32 v121, v34, v35
  v_cvt_pk_bf16_f32 v122, v52, v53
  v_cvt_pk_bf16_f32 v123, v54, v55
  v_cvt_pk_bf16_f32 v124, v56, v57
  v_cvt_pk_bf16_f32 v125, v58, v59
  v_cvt_pk_bf16_f32 v126, v60, v61
  v_cvt_pk_bf16_f32 v127, v62, v63
  v_cvt_pk_bf16_f32 v128, v64, v65
  v_cvt_pk_bf16_f32 v129, v66, v67
  v_cvt_pk_bf16_f32 v130, v68, v69
  v_cvt_pk_bf16_f32 v131, v70, v71
  v_cvt_pk_bf16_f32 v132, v88, v89
  v_cvt_pk_bf16_f32 v133, v90, v91
  v_cvt_pk_bf16_f32 v134, v92, v93
  v_cvt_pk_bf16_f32 v135, v94, v95
  v_cvt_pk_bf16_f32 v136, v96, v97
  v_cvt_pk_bf16_f32 v137, v98, v99
  v_cvt_pk_bf16_f32 v138, v100, v101
  v_cvt_pk_bf16_f32 v139, v102, v103
  v_cvt_pk_bf16_f32 v140, v104, v105
  v_cvt_pk_bf16_f32 v141, v106, v107
  v_lshl_or_b32 v240, v209, 16, v208
  v_lshl_or_b32 v241, v211, 16, v210
  v_lshl_or_b32 v242, v213, 16, v212
  v_lshl_or_b32 v243, v215, 16, v214
  v_lshl_or_b32 v244, v217, 16, v216
  v_lshl_or_b32 v245, v219, 16, v218
  v_lshl_or_b32 v246, v221, 16, v220
  v_lshl_or_b32 v247, v223, 16, v222
  v_lshl_or_b32 v248, v225, 16, v224
  v_lshl_or_b32 v249, v227, 16, v226
  v_lshl_or_b32 v250, v229, 16, v228
  v_lshl_or_b32 v251, v231, 16, v230
  v_lshl_or_b32 v252, v233, 16, v232
  v_lshl_or_b32 v253, v235, 16, v234
  v_lshl_or_b32 v254, v237, 16, v236
  v_lshl_or_b32 v255, v239, 16, v238
  s_lshl_b32 s40, s27, 2
  s_add_u32 s40, s40, s25
  s_lshl_b32 s40, s40, 5
  s_lshl_b32 s41, s30, 2
  s_add_u32 s40, s40, s41
  v_lshlrev_b32 v56, 4, v192
  v_lshlrev_b32 v57, 2, v192
  v_mfma_f32_32x32x16_bf16 v[0:15], v[240:243], v[112:115], 0
  v_mfma_f32_32x32x16_bf16 v[0:15], v[244:247], v[116:119], v[0:15]
  s_nop 11
  v_cvt_pk_bf16_f32 v171, v0, v1
  v_cvt_pk_bf16_f32 v172, v2, v3
  v_cvt_pk_bf16_f32 v173, v4, v5
  v_cvt_pk_bf16_f32 v174, v6, v7
  v_cvt_pk_bf16_f32 v175, v8, v8
  v_lshlrev_b32 v162, 16, v171
  v_and_b32 v163, 0xffff0000, v171
  v_lshlrev_b32 v164, 16, v172
  v_and_b32 v165, 0xffff0000, v172
  v_lshlrev_b32 v166, 16, v173
  v_and_b32 v167, 0xffff0000, v173
  v_lshlrev_b32 v168, 16, v174
  v_and_b32 v169, 0xffff0000, v174
  v_lshlrev_b32 v170, 16, v175
  v_max3_f32 v176, v162, v163, v164
  v_min3_f32 v177, v162, v163, v164
  v_max3_f32 v176, v176, v165, v166
  v_min3_f32 v177, v177, v165, v166
  v_max3_f32 v176, v176, v167, v168
  v_min3_f32 v177, v177, v167, v168
  v_max3_f32 v176, v176, v169, v170
  v_min3_f32 v177, v177, v169, v170
  v_mov_b32 v178, v176
  v_mov_b32 v179, v177
  s_nop 0
  v_permlane32_swap_b32 v176, v178
  v_permlane32_swap_b32 v177, v179
  v_max_f32 v176, v176, v178
  v_min_f32 v177, v177, v179
  v_mul_f32 v176, 0xbfb8aa3b, v176
  v_mul_f32 v177, 0x3fb8aa3b, v177
  v_mov_b32 v178, 0x3fb8aa3b
  v_mov_b32 v179, 0xbfb8aa3b
  v_fma_f32 v0, v162, v178, v176
  v_fma_f32 v180, v162, v179, v177
  v_fma_f32 v1, v163, v178, v176
  v_fma_f32 v181, v163, v179, v177
  v_fma_f32 v2, v164, v178, v176
  v_fma_f32 v182, v164, v179, v177
  v_fma_f32 v3, v165, v178, v176
  v_fma_f32 v183, v165, v179, v177
  v_fma_f32 v4, v166, v178, v176
  v_fma_f32 v184, v166, v179, v177
  v_fma_f32 v5, v167, v178, v176
  v_fma_f32 v185, v167, v179, v177
  v_fma_f32 v6, v168, v178, v176
  v_fma_f32 v186, v168, v179, v177
  v_fma_f32 v7, v169, v178, v176
  v_fma_f32 v187, v169, v179, v177
  v_fma_f32 v8, v170, v178, v176
  v_fma_f32 v188, v170, v179, v177
  v_exp_f32 v0, v0
  v_exp_f32 v180, v180
  v_exp_f32 v1, v1
  v_exp_f32 v181, v181
  v_exp_f32 v2, v2
  v_exp_f32 v182, v182
  v_exp_f32 v3, v3
  v_exp_f32 v183, v183
  v_exp_f32 v4, v4
  v_exp_f32 v184, v184
  v_exp_f32 v5, v5
  v_exp_f32 v185, v185
  v_exp_f32 v6, v6
  v_exp_f32 v186, v186
  v_exp_f32 v7, v7
  v_exp_f32 v187, v187
  v_exp_f32 v8, v8
  v_exp_f32 v188, v188
  v_add_f32 v176, v0, v1
  v_add_f32 v177, v180, v181
  v_add_f32 v176, v176, v2
  v_add_f32 v177, v177, v182
  v_add_f32 v176, v176, v3
  v_add_f32 v177, v177, v183
  v_add_f32 v176, v176, v4
  v_add_f32 v177, v177, v184
  v_add_f32 v176, v176, v5
  v_add_f32 v177, v177, v185
  v_add_f32 v176, v176, v6
  v_add_f32 v177, v177, v186
  v_add_f32 v176, v176, v7
  v_add_f32 v177, v177, v187
  v_add_f32 v176, v176, v8
  v_add_f32 v177, v177, v188
  v_mov_b32 v178, v176
  v_mov_b32 v179, v177
  s_nop 0
  v_permlane32_swap_b32 v176, v178
  v_permlane32_swap_b32 v177, v179
  v_add_f32 v176, v176, v178
  v_add_f32 v177, v177, v179
  v_rcp_f32 v176, v176
  v_rcp_f32 v177, v177
  v_mul_f32 v0, v0, v176
  v_mul_f32 v180, v180, v177
  v_mul_f32 v1, v1, v176
  v_mul_f32 v181, v181, v177
  v_mul_f32 v2, v2, v176
  v_mul_f32 v182, v182, v177
  v_mul_f32 v3, v3, v176
  v_mul_f32 v183, v183, v177
  v_mul_f32 v4, v4, v176
  v_mul_f32 v184, v184, v177
  v_mul_f32 v5, v5, v176
  v_mul_f32 v185, v185, v177
  v_mul_f32 v6, v6, v176
  v_mul_f32 v186, v186, v177
  v_mul_f32 v7, v7, v176
  v_mul_f32 v187, v187, v177
  v_mul_f32 v8, v8, v176
  v_mul_f32 v188, v188, v177
  v_cvt_pk_bf16_f32 v40, v0, v1
  v_cvt_pk_bf16_f32 v41, v2, v3
  v_cvt_pk_bf16_f32 v42, v4, v5
  v_cvt_pk_bf16_f32 v43, v6, v7
  v_cvt_pk_bf16_f32 v44, v8, v8
  v_cvt_pk_bf16_f32 v46, v180, v181
  v_cvt_pk_bf16_f32 v47, v182, v183
  v_cvt_pk_bf16_f32 v48, v184, v185
  v_cvt_pk_bf16_f32 v49, v186, v187
  v_cvt_pk_bf16_f32 v50, v188, v188
  s_add_u32 s41, s40, 2
  s_lshl_b32 s42, s41, 11
  s_add_u32 s42, s42, 2621440
  s_lshl_b32 s43, s41, 8
  s_add_u32 s43, s43, 6815744
  buffer_store_dwordx4 v[40:43], v56, s[16:19], s42 offen sc0 sc1
  buffer_store_dwordx4 v[46:49], v56, s[16:19], s42 offen offset:1024 sc0 sc1
  v_and_b32 v44, 0xffff, v44
  v_lshl_or_b32 v44, v50, 16, v44
  buffer_store_dword v44, v57, s[16:19], s43 offen sc0 sc1
  v_mfma_f32_32x32x16_bf16 v[0:15], v[240:243], v[122:125], 0
  v_mfma_f32_32x32x16_bf16 v[0:15], v[244:247], v[126:129], v[0:15]
  s_nop 11
  v_cvt_pk_bf16_f32 v171, v0, v1
  v_cvt_pk_bf16_f32 v172, v2, v3
  v_cvt_pk_bf16_f32 v173, v4, v5
  v_cvt_pk_bf16_f32 v174, v6, v7
  v_cvt_pk_bf16_f32 v175, v8, v8
  v_lshlrev_b32 v162, 16, v171
  v_and_b32 v163, 0xffff0000, v171
  v_lshlrev_b32 v164, 16, v172
  v_and_b32 v165, 0xffff0000, v172
  v_lshlrev_b32 v166, 16, v173
  v_and_b32 v167, 0xffff0000, v173
  v_lshlrev_b32 v168, 16, v174
  v_and_b32 v169, 0xffff0000, v174
  v_lshlrev_b32 v170, 16, v175
  v_max3_f32 v176, v162, v163, v164
  v_min3_f32 v177, v162, v163, v164
  v_max3_f32 v176, v176, v165, v166
  v_min3_f32 v177, v177, v165, v166
  v_max3_f32 v176, v176, v167, v168
  v_min3_f32 v177, v177, v167, v168
  v_max3_f32 v176, v176, v169, v170
  v_min3_f32 v177, v177, v169, v170
  v_mov_b32 v178, v176
  v_mov_b32 v179, v177
  s_nop 0
  v_permlane32_swap_b32 v176, v178
  v_permlane32_swap_b32 v177, v179
  v_max_f32 v176, v176, v178
  v_min_f32 v177, v177, v179
  v_mul_f32 v176, 0xbfb8aa3b, v176
  v_mul_f32 v177, 0x3fb8aa3b, v177
  v_mov_b32 v178, 0x3fb8aa3b
  v_mov_b32 v179, 0xbfb8aa3b
  v_fma_f32 v0, v162, v178, v176
  v_fma_f32 v180, v162, v179, v177
  v_fma_f32 v1, v163, v178, v176
  v_fma_f32 v181, v163, v179, v177
  v_fma_f32 v2, v164, v178, v176
  v_fma_f32 v182, v164, v179, v177
  v_fma_f32 v3, v165, v178, v176
  v_fma_f32 v183, v165, v179, v177
  v_fma_f32 v4, v166, v178, v176
  v_fma_f32 v184, v166, v179, v177
  v_fma_f32 v5, v167, v178, v176
  v_fma_f32 v185, v167, v179, v177
  v_fma_f32 v6, v168, v178, v176
  v_fma_f32 v186, v168, v179, v177
  v_fma_f32 v7, v169, v178, v176
  v_fma_f32 v187, v169, v179, v177
  v_fma_f32 v8, v170, v178, v176
  v_fma_f32 v188, v170, v179, v177
  v_exp_f32 v0, v0
  v_exp_f32 v180, v180
  v_exp_f32 v1, v1
  v_exp_f32 v181, v181
  v_exp_f32 v2, v2
  v_exp_f32 v182, v182
  v_exp_f32 v3, v3
  v_exp_f32 v183, v183
  v_exp_f32 v4, v4
  v_exp_f32 v184, v184
  v_exp_f32 v5, v5
  v_exp_f32 v185, v185
  v_exp_f32 v6, v6
  v_exp_f32 v186, v186
  v_exp_f32 v7, v7
  v_exp_f32 v187, v187
  v_exp_f32 v8, v8
  v_exp_f32 v188, v188
  v_add_f32 v176, v0, v1
  v_add_f32 v177, v180, v181
  v_add_f32 v176, v176, v2
  v_add_f32 v177, v177, v182
  v_add_f32 v176, v176, v3
  v_add_f32 v177, v177, v183
  v_add_f32 v176, v176, v4
  v_add_f32 v177, v177, v184
  v_add_f32 v176, v176, v5
  v_add_f32 v177, v177, v185
  v_add_f32 v176, v176, v6
  v_add_f32 v177, v177, v186
  v_add_f32 v176, v176, v7
  v_add_f32 v177, v177, v187
  v_add_f32 v176, v176, v8
  v_add_f32 v177, v177, v188
  v_mov_b32 v178, v176
  v_mov_b32 v179, v177
  s_nop 0
  v_permlane32_swap_b32 v176, v178
  v_permlane32_swap_b32 v177, v179
  v_add_f32 v176, v176, v178
  v_add_f32 v177, v177, v179
  v_rcp_f32 v176, v176
  v_rcp_f32 v177, v177
  v_mul_f32 v0, v0, v176
  v_mul_f32 v180, v180, v177
  v_mul_f32 v1, v1, v176
  v_mul_f32 v181, v181, v177
  v_mul_f32 v2, v2, v176
  v_mul_f32 v182, v182, v177
  v_mul_f32 v3, v3, v176
  v_mul_f32 v183, v183, v177
  v_mul_f32 v4, v4, v176
  v_mul_f32 v184, v184, v177
  v_mul_f32 v5, v5, v176
  v_mul_f32 v185, v185, v177
  v_mul_f32 v6, v6, v176
  v_mul_f32 v186, v186, v177
  v_mul_f32 v7, v7, v176
  v_mul_f32 v187, v187, v177
  v_mul_f32 v8, v8, v176
  v_mul_f32 v188, v188, v177
  v_cvt_pk_bf16_f32 v16, v0, v1
  v_cvt_pk_bf16_f32 v17, v2, v3
  v_cvt_pk_bf16_f32 v18, v4, v5
  v_cvt_pk_bf16_f32 v19, v6, v7
  v_cvt_pk_bf16_f32 v20, v8, v8
  v_cvt_pk_bf16_f32 v22, v180, v181
  v_cvt_pk_bf16_f32 v23, v182, v183
  v_cvt_pk_bf16_f32 v24, v184, v185
  v_cvt_pk_bf16_f32 v25, v186, v187
  v_cvt_pk_bf16_f32 v26, v188, v188
  v_mfma_f32_32x32x16_bf16 v[0:15], v[248:251], v[116:119], 0
  v_mov_b32 v52, v120
  v_mov_b32 v53, v121
  v_mov_b32 v54, 0
  v_mov_b32 v55, 0
  s_nop 1
  v_mfma_f32_32x32x16_bf16 v[0:15], v[252:255], v[52:55], v[0:15]
  s_nop 11
  v_cvt_pk_bf16_f32 v171, v0, v1
  v_cvt_pk_bf16_f32 v172, v2, v3
  v_cvt_pk_bf16_f32 v173, v4, v5
  v_cvt_pk_bf16_f32 v174, v6, v7
  v_cvt_pk_bf16_f32 v175, v8, v8
  v_lshlrev_b32 v162, 16, v171
  v_and_b32 v163, 0xffff0000, v171
  v_lshlrev_b32 v164, 16, v172
  v_and_b32 v165, 0xffff0000, v172
  v_lshlrev_b32 v166, 16, v173
  v_and_b32 v167, 0xffff0000, v173
  v_lshlrev_b32 v168, 16, v174
  v_and_b32 v169, 0xffff0000, v174
  v_lshlrev_b32 v170, 16, v175
  v_max3_f32 v176, v162, v163, v164
  v_min3_f32 v177, v162, v163, v164
  v_max3_f32 v176, v176, v165, v166
  v_min3_f32 v177, v177, v165, v166
  v_max3_f32 v176, v176, v167, v168
  v_min3_f32 v177, v177, v167, v168
  v_max3_f32 v176, v176, v169, v170
  v_min3_f32 v177, v177, v169, v170
  v_mov_b32 v178, v176
  v_mov_b32 v179, v177
  s_nop 0
  v_permlane32_swap_b32 v176, v178
  v_permlane32_swap_b32 v177, v179
  v_max_f32 v176, v176, v178
  v_min_f32 v177, v177, v179
  v_mul_f32 v176, 0xbfb8aa3b, v176
  v_mul_f32 v177, 0x3fb8aa3b, v177
  v_mov_b32 v178, 0x3fb8aa3b
  v_mov_b32 v179, 0xbfb8aa3b
  v_fma_f32 v0, v162, v178, v176
  v_fma_f32 v180, v162, v179, v177
  v_fma_f32 v1, v163, v178, v176
  v_fma_f32 v181, v163, v179, v177
  v_fma_f32 v2, v164, v178, v176
  v_fma_f32 v182, v164, v179, v177
  v_fma_f32 v3, v165, v178, v176
  v_fma_f32 v183, v165, v179, v177
  v_fma_f32 v4, v166, v178, v176
  v_fma_f32 v184, v166, v179, v177
  v_fma_f32 v5, v167, v178, v176
  v_fma_f32 v185, v167, v179, v177
  v_fma_f32 v6, v168, v178, v176
  v_fma_f32 v186, v168, v179, v177
  v_fma_f32 v7, v169, v178, v176
  v_fma_f32 v187, v169, v179, v177
  v_fma_f32 v8, v170, v178, v176
  v_fma_f32 v188, v170, v179, v177
  v_exp_f32 v0, v0
  v_exp_f32 v180, v180
  v_exp_f32 v1, v1
  v_exp_f32 v181, v181
  v_exp_f32 v2, v2
  v_exp_f32 v182, v182
  v_exp_f32 v3, v3
  v_exp_f32 v183, v183
  v_exp_f32 v4, v4
  v_exp_f32 v184, v184
  v_exp_f32 v5, v5
  v_exp_f32 v185, v185
  v_exp_f32 v6, v6
  v_exp_f32 v186, v186
  v_exp_f32 v7, v7
  v_exp_f32 v187, v187
  v_exp_f32 v8, v8
  v_exp_f32 v188, v188
  v_add_f32 v176, v0, v1
  v_add_f32 v177, v180, v181
  v_add_f32 v176, v176, v2
  v_add_f32 v177, v177, v182
  v_add_f32 v176, v176, v3
  v_add_f32 v177, v177, v183
  v_add_f32 v176, v176, v4
  v_add_f32 v177, v177, v184
  v_add_f32 v176, v176, v5
  v_add_f32 v177, v177, v185
  v_add_f32 v176, v176, v6
  v_add_f32 v177, v177, v186
  v_add_f32 v176, v176, v7
  v_add_f32 v177, v177, v187
  v_add_f32 v176, v176, v8
  v_add_f32 v177, v177, v188
  v_mov_b32 v178, v176
  v_mov_b32 v179, v177
  s_nop 0
  v_permlane32_swap_b32 v176, v178
  v_permlane32_swap_b32 v177, v179
  v_add_f32 v176, v176, v178
  v_add_f32 v177, v177, v179
  v_rcp_f32 v176, v176
  v_rcp_f32 v177, v177
  v_mul_f32 v0, v0, v176
  v_mul_f32 v180, v180, v177
  v_mul_f32 v1, v1, v176
  v_mul_f32 v181, v181, v177
  v_mul_f32 v2, v2, v176
  v_mul_f32 v182, v182, v177
  v_mul_f32 v3, v3, v176
  v_mul_f32 v183, v183, v177
  v_mul_f32 v4, v4, v176
  v_mul_f32 v184, v184, v177
  v_mul_f32 v5, v5, v176
  v_mul_f32 v185, v185, v177
  v_mul_f32 v6, v6, v176
  v_mul_f32 v186, v186, v177
  v_mul_f32 v7, v7, v176
  v_mul_f32 v187, v187, v177
  v_mul_f32 v8, v8, v176
  v_mul_f32 v188, v188, v177
  v_cvt_pk_bf16_f32 v40, v0, v1
  v_cvt_pk_bf16_f32 v41, v2, v3
  v_cvt_pk_bf16_f32 v42, v4, v5
  v_cvt_pk_bf16_f32 v43, v6, v7
  v_cvt_pk_bf16_f32 v44, v8, v8
  v_cvt_pk_bf16_f32 v46, v180, v181
  v_cvt_pk_bf16_f32 v47, v182, v183
  v_cvt_pk_bf16_f32 v48, v184, v185
  v_cvt_pk_bf16_f32 v49, v186, v187
  v_cvt_pk_bf16_f32 v50, v188, v188
  s_add_u32 s41, s40, 3
  s_lshl_b32 s42, s41, 11
  s_add_u32 s42, s42, 2621440
  s_lshl_b32 s43, s41, 8
  s_add_u32 s43, s43, 6815744
  buffer_store_dwordx4 v[40:43], v56, s[16:19], s42 offen sc0 sc1
  buffer_store_dwordx4 v[46:49], v56, s[16:19], s42 offen offset:1024 sc0 sc1
  v_and_b32 v44, 0xffff, v44
  v_lshl_or_b32 v44, v50, 16, v44
  buffer_store_dword v44, v57, s[16:19], s43 offen sc0 sc1
  v_mfma_f32_32x32x16_bf16 v[0:15], v[248:251], v[126:129], 0
  v_mov_b32 v52, v130
  v_mov_b32 v53, v131
  v_mov_b32 v54, 0
  v_mov_b32 v55, 0
  s_nop 1
  v_mfma_f32_32x32x16_bf16 v[0:15], v[252:255], v[52:55], v[0:15]
  s_nop 11
  v_cvt_pk_bf16_f32 v171, v0, v1
  v_cvt_pk_bf16_f32 v172, v2, v3
  v_cvt_pk_bf16_f32 v173, v4, v5
  v_cvt_pk_bf16_f32 v174, v6, v7
  v_cvt_pk_bf16_f32 v175, v8, v8
  v_lshlrev_b32 v162, 16, v171
  v_and_b32 v163, 0xffff0000, v171
  v_lshlrev_b32 v164, 16, v172
  v_and_b32 v165, 0xffff0000, v172
  v_lshlrev_b32 v166, 16, v173
  v_and_b32 v167, 0xffff0000, v173
  v_lshlrev_b32 v168, 16, v174
  v_and_b32 v169, 0xffff0000, v174
  v_lshlrev_b32 v170, 16, v175
  v_max3_f32 v176, v162, v163, v164
  v_min3_f32 v177, v162, v163, v164
  v_max3_f32 v176, v176, v165, v166
  v_min3_f32 v177, v177, v165, v166
  v_max3_f32 v176, v176, v167, v168
  v_min3_f32 v177, v177, v167, v168
  v_max3_f32 v176, v176, v169, v170
  v_min3_f32 v177, v177, v169, v170
  v_mov_b32 v178, v176
  v_mov_b32 v179, v177
  s_nop 0
  v_permlane32_swap_b32 v176, v178
  v_permlane32_swap_b32 v177, v179
  v_max_f32 v176, v176, v178
  v_min_f32 v177, v177, v179
  v_mul_f32 v176, 0xbfb8aa3b, v176
  v_mul_f32 v177, 0x3fb8aa3b, v177
  v_mov_b32 v178, 0x3fb8aa3b
  v_mov_b32 v179, 0xbfb8aa3b
  v_fma_f32 v0, v162, v178, v176
  v_fma_f32 v180, v162, v179, v177
  v_fma_f32 v1, v163, v178, v176
  v_fma_f32 v181, v163, v179, v177
  v_fma_f32 v2, v164, v178, v176
  v_fma_f32 v182, v164, v179, v177
  v_fma_f32 v3, v165, v178, v176
  v_fma_f32 v183, v165, v179, v177
  v_fma_f32 v4, v166, v178, v176
  v_fma_f32 v184, v166, v179, v177
  v_fma_f32 v5, v167, v178, v176
  v_fma_f32 v185, v167, v179, v177
  v_fma_f32 v6, v168, v178, v176
  v_fma_f32 v186, v168, v179, v177
  v_fma_f32 v7, v169, v178, v176
  v_fma_f32 v187, v169, v179, v177
  v_fma_f32 v8, v170, v178, v176
  v_fma_f32 v188, v170, v179, v177
  v_exp_f32 v0, v0
  v_exp_f32 v180, v180
  v_exp_f32 v1, v1
  v_exp_f32 v181, v181
  v_exp_f32 v2, v2
  v_exp_f32 v182, v182
  v_exp_f32 v3, v3
  v_exp_f32 v183, v183
  v_exp_f32 v4, v4
  v_exp_f32 v184, v184
  v_exp_f32 v5, v5
  v_exp_f32 v185, v185
  v_exp_f32 v6, v6
  v_exp_f32 v186, v186
  v_exp_f32 v7, v7
  v_exp_f32 v187, v187
  v_exp_f32 v8, v8
  v_exp_f32 v188, v188
  v_add_f32 v176, v0, v1
  v_add_f32 v177, v180, v181
  v_add_f32 v176, v176, v2
  v_add_f32 v177, v177, v182
  v_add_f32 v176, v176, v3
  v_add_f32 v177, v177, v183
  v_add_f32 v176, v176, v4
  v_add_f32 v177, v177, v184
  v_add_f32 v176, v176, v5
  v_add_f32 v177, v177, v185
  v_add_f32 v176, v176, v6
  v_add_f32 v177, v177, v186
  v_add_f32 v176, v176, v7
  v_add_f32 v177, v177, v187
  v_add_f32 v176, v176, v8
  v_add_f32 v177, v177, v188
  v_mov_b32 v178, v176
  v_mov_b32 v179, v177
  s_nop 0
  v_permlane32_swap_b32 v176, v178
  v_permlane32_swap_b32 v177, v179
  v_add_f32 v176, v176, v178
  v_add_f32 v177, v177, v179
  v_rcp_f32 v176, v176
  v_rcp_f32 v177, v177
  v_mul_f32 v0, v0, v176
  v_mul_f32 v180, v180, v177
  v_mul_f32 v1, v1, v176
  v_mul_f32 v181, v181, v177
  v_mul_f32 v2, v2, v176
  v_mul_f32 v182, v182, v177
  v_mul_f32 v3, v3, v176
  v_mul_f32 v183, v183, v177
  v_mul_f32 v4, v4, v176
  v_mul_f32 v184, v184, v177
  v_mul_f32 v5, v5, v176
  v_mul_f32 v185, v185, v177
  v_mul_f32 v6, v6, v176
  v_mul_f32 v186, v186, v177
  v_mul_f32 v7, v7, v176
  v_mul_f32 v187, v187, v177
  v_mul_f32 v8, v8, v176
  v_mul_f32 v188, v188, v177
  v_cvt_pk_bf16_f32 v28, v0, v1
  v_cvt_pk_bf16_f32 v29, v2, v3
  v_cvt_pk_bf16_f32 v30, v4, v5
  v_cvt_pk_bf16_f32 v31, v6, v7
  v_cvt_pk_bf16_f32 v32, v8, v8
  v_cvt_pk_bf16_f32 v34, v180, v181
  v_cvt_pk_bf16_f32 v35, v182, v183
  v_cvt_pk_bf16_f32 v36, v184, v185
  v_cvt_pk_bf16_f32 v37, v186, v187
  v_cvt_pk_bf16_f32 v38, v188, v188
  s_barrier
  v_and_b32 v162, 31, v192
  v_lshrrev_b32 v163, 5, v192
  s_lshl_b32 s40, s25, 5
  v_add_u32 v162, s40, v162
  v_mul_u32_u24 v162, 584, v162
  v_lshl_add_u32 v190, v163, 3, v162
  v_mul_u32_u24 v163, 12, v163
  v_add_u32 v191, v163, v162
  ds_write_b64 v190, v[16:17] offset:192
  ds_write_b64 v190, v[18:19] offset:208
  ds_write_b16 v190, v20 offset:224
  ds_write_b64 v190, v[22:23] offset:240
  ds_write_b64 v190, v[24:25] offset:256
  ds_write_b16 v190, v26 offset:272
  ds_write_b64 v190, v[28:29] offset:288
  ds_write_b64 v190, v[30:31] offset:304
  ds_write_b16 v190, v32 offset:320
  ds_write_b64 v190, v[34:35] offset:336
  ds_write_b64 v190, v[36:37] offset:352
  ds_write_b16 v190, v38 offset:368
  ds_write_b32 v191, v132 offset:452
  ds_write_b32 v191, v133 offset:456
  ds_write_b32 v190, v134 offset:472
  s_waitcnt lgkmcnt(13)
  ds_write_b32 v190, v135 offset:476
  ds_write_b32 v190, v136 offset:488
  s_waitcnt lgkmcnt(13)
  ds_write_b32 v191, v137 offset:492
  ds_write_b32 v190, v138 offset:508
  s_waitcnt lgkmcnt(13)
  ds_write_b32 v190, v139 offset:512
  ds_write_b32 v190, v140 offset:524
  s_waitcnt lgkmcnt(13)
  ds_write_b32 v190, v141 offset:528
  s_waitcnt lgkmcnt(0)
  s_barrier
  s_mul_i32 s42, s24, 24
  s_lshr_b32 s43, s24, 1
  s_mul_i32 s43, s43, 20
  s_add_u32 s43, s43, 192
  s_lshl_b32 s46, s30, 3
  s_add_u32 s46, s46, s24
  s_add_u32 s46, s46, 32
  v_lshrrev_b32 v162, 5, v192
  v_lshrrev_b32 v163, 4, v192
  v_and_b32 v163, 1, v163
  v_and_b32 v164, 15, v192
  v_lshrrev_b32 v165, 2, v164
  v_and_b32 v166, 3, v164
  v_lshl_add_u32 v167, v162, 3, v165
  v_mul_u32_u24 v167, 584, v167
  v_lshlrev_b32 v168, 5, v163
  v_lshl_add_u32 v168, v166, 3, v168
  v_add_u32 v167, v167, v168
  s_lshl_b32 s42, s42, 1
  s_lshl_b32 s43, s43, 1
  v_add_u32 v168, s42, v167
  v_add_u32 v169, s43, v167
  v_add_u32 v170, 37376, v168
  v_add_u32 v171, 37376, v169
  v_mov_b32 v172, 0x3f803f80
  s_mov_b32 s44, 0x00440000
  s_mov_b32 s45, 0x00440000
  ds_read_b64_tr_b16 v[0:1], v168 offset:0
  ds_read_b64_tr_b16 v[32:33], v169 offset:0
  ds_read_b64_tr_b16 v[2:3], v168 offset:2336
  ds_read_b64_tr_b16 v[34:35], v169 offset:2336
  ds_read_b64_tr_b16 v[4:5], v168 offset:9344
  ds_read_b64_tr_b16 v[36:37], v169 offset:9344
  ds_read_b64_tr_b16 v[6:7], v168 offset:11680
  ds_read_b64_tr_b16 v[38:39], v169 offset:11680
  ds_read_b64_tr_b16 v[8:9], v168 offset:18688
  ds_read_b64_tr_b16 v[40:41], v169 offset:18688
  ds_read_b64_tr_b16 v[10:11], v168 offset:21024
  ds_read_b64_tr_b16 v[42:43], v169 offset:21024
  ds_read_b64_tr_b16 v[12:13], v168 offset:28032
  ds_read_b64_tr_b16 v[44:45], v169 offset:28032
  ds_read_b64_tr_b16 v[14:15], v168 offset:30368
  s_waitcnt lgkmcnt(13)
  ds_read_b64_tr_b16 v[46:47], v169 offset:30368
  ds_read_b64_tr_b16 v[16:17], v170 offset:0
  s_waitcnt lgkmcnt(13)
  ds_read_b64_tr_b16 v[48:49], v171 offset:0
  ds_read_b64_tr_b16 v[18:19], v170 offset:2336
  s_waitcnt lgkmcnt(13)
  ds_read_b64_tr_b16 v[50:51], v171 offset:2336
  ds_read_b64_tr_b16 v[20:21], v170 offset:9344
  s_waitcnt lgkmcnt(13)
  ds_read_b64_tr_b16 v[52:53], v171 offset:9344
  ds_read_b64_tr_b16 v[22:23], v170 offset:11680
  s_waitcnt lgkmcnt(13)
  ds_read_b64_tr_b16 v[54:55], v171 offset:11680
  ds_read_b64_tr_b16 v[24:25], v170 offset:18688
  s_waitcnt lgkmcnt(13)
  ds_read_b64_tr_b16 v[56:57], v171 offset:18688
  ds_read_b64_tr_b16 v[26:27], v170 offset:21024
  s_waitcnt lgkmcnt(13)
  ds_read_b64_tr_b16 v[58:59], v171 offset:21024
  ds_read_b64_tr_b16 v[28:29], v170 offset:28032
  s_waitcnt lgkmcnt(13)
  ds_read_b64_tr_b16 v[60:61], v171 offset:28032
  ds_read_b64_tr_b16 v[30:31], v170 offset:30368
  s_waitcnt lgkmcnt(13)
  ds_read_b64_tr_b16 v[62:63], v171 offset:30368
  v_cndmask_b32 v32, v32, v172, s[44:45]
  v_cndmask_b32 v33, v33, v172, s[44:45]
  v_cndmask_b32 v34, v34, v172, s[44:45]
  v_cndmask_b32 v35, v35, v172, s[44:45]
  s_nop 1
  v_mfma_f32_32x32x16_bf16 v[64:79], v[0:3], v[32:35], 0
  v_cndmask_b32 v36, v36, v172, s[44:45]
  v_cndmask_b32 v37, v37, v172, s[44:45]
  v_cndmask_b32 v38, v38, v172, s[44:45]
  v_cndmask_b32 v39, v39, v172, s[44:45]
  s_nop 1
  v_mfma_f32_32x32x16_bf16 v[64:79], v[4:7], v[36:39], v[64:79]
  v_cndmask_b32 v40, v40, v172, s[44:45]
  v_cndmask_b32 v41, v41, v172, s[44:45]
  v_cndmask_b32 v42, v42, v172, s[44:45]
  v_cndmask_b32 v43, v43, v172, s[44:45]
  s_nop 1
  v_mfma_f32_32x32x16_bf16 v[64:79], v[8:11], v[40:43], v[64:79]
  v_cndmask_b32 v44, v44, v172, s[44:45]
  v_cndmask_b32 v45, v45, v172, s[44:45]
  v_cndmask_b32 v46, v46, v172, s[44:45]
  v_cndmask_b32 v47, v47, v172, s[44:45]
  s_nop 1
  v_mfma_f32_32x32x16_bf16 v[64:79], v[12:15], v[44:47], v[64:79]
  v_cndmask_b32 v48, v48, v172, s[44:45]
  v_cndmask_b32 v49, v49, v172, s[44:45]
  s_waitcnt lgkmcnt(12)
  v_cndmask_b32 v50, v50, v172, s[44:45]
  v_cndmask_b32 v51, v51, v172, s[44:45]
  s_nop 1
  v_mfma_f32_32x32x16_bf16 v[64:79], v[16:19], v[48:51], v[64:79]
  s_waitcnt lgkmcnt(10)
  v_cndmask_b32 v52, v52, v172, s[44:45]
  v_cndmask_b32 v53, v53, v172, s[44:45]
  s_waitcnt lgkmcnt(8)
  v_cndmask_b32 v54, v54, v172, s[44:45]
  v_cndmask_b32 v55, v55, v172, s[44:45]
  s_nop 1
  v_mfma_f32_32x32x16_bf16 v[64:79], v[20:23], v[52:55], v[64:79]
  s_waitcnt lgkmcnt(6)
  v_cndmask_b32 v56, v56, v172, s[44:45]
  v_cndmask_b32 v57, v57, v172, s[44:45]
  s_waitcnt lgkmcnt(4)
  v_cndmask_b32 v58, v58, v172, s[44:45]
  v_cndmask_b32 v59, v59, v172, s[44:45]
  s_nop 1
  v_mfma_f32_32x32x16_bf16 v[64:79], v[24:27], v[56:59], v[64:79]
  s_waitcnt lgkmcnt(2)
  v_cndmask_b32 v60, v60, v172, s[44:45]
  v_cndmask_b32 v61, v61, v172, s[44:45]
  s_waitcnt lgkmcnt(0)
  v_cndmask_b32 v62, v62, v172, s[44:45]
  v_cndmask_b32 v63, v63, v172, s[44:45]
  s_nop 1
  v_mfma_f32_32x32x16_bf16 v[64:79], v[28:31], v[60:63], v[64:79]
  s_mul_i32 s40, s27, 96
  s_add_u32 s40, s40, s46
  s_mul_i32 s40, s40, 3072
  s_add_u32 s40, s40, 7340032
  v_lshlrev_b32 v162, 4, v192
  s_nop 6
  buffer_store_dwordx4 v[64:67], v162, s[16:19], s40 offen offset:0 sc0 sc1
  buffer_store_dwordx4 v[68:71], v162, s[16:19], s40 offen offset:1024 sc0 sc1
  buffer_store_dwordx4 v[72:75], v162, s[16:19], s40 offen offset:2048 sc0 sc1
  s_endpgm
k1_end:
  s_waitcnt vmcnt(0)
  s_nop 15
  s_nop 7
  s_endpgm
.globl k2a_kernel
.p2align 8
.type k2a_kernel,@function
k2a_kernel:
  s_cmp_ge_u32 s2, 256
  s_cbranch_scc1 k2a_end
  s_load_dwordx2 s[4:5], s[0:1], 80
  v_lshrrev_b32 v202, 6, v0
  v_and_b32 v200, 63, v0
  v_readfirstlane_b32 s24, v202
  s_waitcnt lgkmcnt(0)
  s_mov_b32 s8, s4
  s_and_b32 s9, s5, 0xffff
  s_mov_b32 s10, 0x10000000
  s_mov_b32 s11, 0x20000
  s_and_b32 s30, s2, 63
  s_lshr_b32 s31, s2, 6
  s_and_b32 s32, s30, 31
  s_lshr_b32 s29, s30, 5
  s_and_b32 s37, s32, 3
  s_lshr_b32 s36, s32, 2
  s_lshl_b32 s34, s37, 1
  s_lshl_b32 s35, s31, 4
  s_lshl_b32 s40, s24, 2
  s_add_u32 s35, s35, s40
  s_mul_i32 s40, s29, 18
  s_lshr_b32 s41, s32, 1
  s_add_u32 s40, s40, s41
  s_lshl_b32 s40, s40, 7
  s_lshl_b32 s41, s35, 1
  s_add_u32 s40, s40, s41
  s_lshl_b32 s40, s40, 10
  s_and_b32 s41, s32, 1
  s_lshl_b32 s41, s41, 9
  s_add_u32 s40, s40, s41
  s_add_u32 s38, s40, 12058624
  s_mul_i32 s40, s29, 18
  s_lshr_b32 s41, s32, 4
  s_add_u32 s40, s40, s41
  s_add_u32 s40, s40, 16
  s_lshl_b32 s40, s40, 7
  s_lshl_b32 s41, s35, 1
  s_add_u32 s40, s40, s41
  s_lshl_b32 s40, s40, 10
  s_and_b32 s41, s32, 15
  s_lshr_b32 s41, s41, 2
  s_lshl_b32 s41, s41, 8
  s_add_u32 s40, s40, s41
  s_and_b32 s41, s32, 3
  s_lshl_b32 s41, s41, 2
  s_add_u32 s40, s40, s41
  s_add_u32 s39, s40, 12058624
  v_bfe_u32 v204, v200, 4, 1
  v_lshlrev_b32 v204, 10, v204
  v_and_b32 v205, 15, v200
  v_lshl_add_u32 v204, v205, 4, v204
  v_lshrrev_b32 v205, 5, v200
  v_lshl_add_u32 v208, v205, 8, v204
  v_mov_b32 v206, 0x7fff0000
  v_cmp_eq_u32 vcc, 0, v205
  s_nop 1
  v_cndmask_b32 v209, v206, v204, vcc
  v_lshlrev_b32 v210, 2, v200
  s_cmp_eq_u32 s29, 0
  s_cbranch_scc0 k2a_b
  s_mov_b32 s33, s32
  v_lshlrev_b32 v202, 4, v200
  s_lshl_b32 s40, s24, 2
  s_add_u32 s40, s40, 0
  s_mul_i32 s40, s40, 96
  s_add_u32 s40, s40, s33
  s_add_u32 s40, s40, 0
  s_mul_i32 s40, s40, 3072
  s_add_u32 s40, s40, 7340032
  buffer_load_dwordx4 v[0:3], v202, s[8:11], s40 offen offset:0
  buffer_load_dwordx4 v[4:7], v202, s[8:11], s40 offen offset:1024
  buffer_load_dwordx4 v[8:11], v202, s[8:11], s40 offen offset:2048
  s_lshl_b32 s40, s24, 2
  s_add_u32 s40, s40, 1
  s_mul_i32 s40, s40, 96
  s_add_u32 s40, s40, s33
  s_add_u32 s40, s40, 0
  s_mul_i32 s40, s40, 3072
  s_add_u32 s40, s40, 7340032
  buffer_load_dwordx4 v[12:15], v202, s[8:11], s40 offen offset:0
  buffer_load_dwordx4 v[16:19], v202, s[8:11], s40 offen offset:1024
  buffer_load_dwordx4 v[20:23], v202, s[8:11], s40 offen offset:2048
  s_lshl_b32 s40, s24, 2
  s_add_u32 s40, s40, 2
  s_mul_i32 s40, s40, 96
  s_add_u32 s40, s40, s33
  s_add_u32 s40, s40, 0
  s_mul_i32 s40, s40, 3072
  s_add_u32 s40, s40, 7340032
  buffer_load_dwordx4 v[24:27], v202, s[8:11], s40 offen offset:0
  buffer_load_dwordx4 v[28:31], v202, s[8:11], s40 offen offset:1024
  buffer_load_dwordx4 v[32:35], v202, s[8:11], s40 offen offset:2048
  s_lshl_b32 s40, s24, 2
  s_add_u32 s40, s40, 3
  s_mul_i32 s40, s40, 96
  s_add_u32 s40, s40, s33
  s_add_u32 s40, s40, 0
  s_mul_i32 s40, s40, 3072
  s_add_u32 s40, s40, 7340032
  buffer_load_dwordx4 v[36:39], v202, s[8:11], s40 offen offset:0
  buffer_load_dwordx4 v[40:43], v202, s[8:11], s40 offen offset:1024
  buffer_load_dwordx4 v[44:47], v202, s[8:11], s40 offen offset:2048
  s_add_u32 s40, s35, 0
  s_lshl_b32 s40, s40, 3
  s_add_u32 s40, s40, s36
  s_mul_i32 s40, s40, 5
  s_add_u32 s40, s40, s37
  s_lshl_b32 s40, s40, 10
  s_add_u32 s40, s40, 0
  buffer_load_dwordx4 v[100:103], v202, s[8:11], s40 offen offset:0
  buffer_load_dwordx4 v[104:107], v202, s[8:11], s40 offen offset:1024
  s_add_u32 s40, s35, 1
  s_lshl_b32 s40, s40, 3
  s_add_u32 s40, s40, s36
  s_mul_i32 s40, s40, 5
  s_add_u32 s40, s40, s37
  s_lshl_b32 s40, s40, 10
  s_add_u32 s40, s40, 0
  buffer_load_dwordx4 v[112:115], v202, s[8:11], s40 offen offset:0
  buffer_load_dwordx4 v[116:119], v202, s[8:11], s40 offen offset:1024
  s_add_u32 s40, s35, 2
  s_lshl_b32 s40, s40, 3
  s_add_u32 s40, s40, s36
  s_mul_i32 s40, s40, 5
  s_add_u32 s40, s40, s37
  s_lshl_b32 s40, s40, 10
  s_add_u32 s40, s40, 0
  buffer_load_dwordx4 v[124:127], v202, s[8:11], s40 offen offset:0
  buffer_load_dwordx4 v[128:131], v202, s[8:11], s40 offen offset:1024
  s_add_u32 s40, s35, 3
  s_lshl_b32 s40, s40, 3
  s_add_u32 s40, s40, s36
  s_mul_i32 s40, s40, 5
  s_add_u32 s40, s40, s37
  s_lshl_b32 s40, s40, 10
  s_add_u32 s40, s40, 0
  buffer_load_dwordx4 v[136:139], v202, s[8:11], s40 offen offset:0
  buffer_load_dwordx4 v[140:143], v202, s[8:11], s40 offen offset:1024
  s_waitcnt vmcnt(16)
  v_add_f32 v0, v0, v12
  s_waitcnt vmcnt(10)
  v_add_f32 v24, v24, v36
  v_add_f32 v1, v1, v13
  v_add_f32 v25, v25, v37
  v_add_f32 v2, v2, v14
  v_add_f32 v26, v26, v38
  v_add_f32 v3, v3, v15
  v_add_f32 v27, v27, v39
  v_add_f32 v4, v4, v16
  s_waitcnt vmcnt(9)
  v_add_f32 v28, v28, v40
  v_add_f32 v5, v5, v17
  v_add_f32 v29, v29, v41
  v_add_f32 v6, v6, v18
  v_add_f32 v30, v30, v42
  v_add_f32 v7, v7, v19
  v_add_f32 v31, v31, v43
  v_add_f32 v8, v8, v20
  s_waitcnt vmcnt(8)
  v_add_f32 v32, v32, v44
  v_add_f32 v9, v9, v21
  v_add_f32 v33, v33, v45
  v_add_f32 v10, v10, v22
  v_add_f32 v34, v34, v46
  v_add_f32 v11, v11, v23
  v_add_f32 v35, v35, v47
  v_add_f32 v0, v0, v24
  v_add_f32 v1, v1, v25
  v_add_f32 v2, v2, v26
  v_add_f32 v3, v3, v27
  v_add_f32 v4, v4, v28
  v_add_f32 v5, v5, v29
  v_add_f32 v6, v6, v30
  v_add_f32 v7, v7, v31
  v_add_f32 v8, v8, v32
  v_add_f32 v9, v9, v33
  v_add_f32 v10, v10, v34
  v_add_f32 v11, v11, v35
  s_mul_i32 s40, s24, 6144
  v_add_u32 v203, s40, v202
  ds_write_b128 v203, v[0:3] offset:0
  ds_write_b128 v203, v[4:7] offset:1024
  ds_write_b128 v203, v[8:11] offset:2048
  s_waitcnt lgkmcnt(0)
  s_barrier
  ds_read_b128 v[0:3], v202 offset:0
  ds_read_b128 v[4:7], v202 offset:1024
  ds_read_b128 v[8:11], v202 offset:2048
  ds_read_b128 v[12:15], v202 offset:6144
  ds_read_b128 v[16:19], v202 offset:7168
  ds_read_b128 v[20:23], v202 offset:8192
  ds_read_b128 v[24:27], v202 offset:12288
  ds_read_b128 v[28:31], v202 offset:13312
  ds_read_b128 v[32:35], v202 offset:14336
  ds_read_b128 v[36:39], v202 offset:18432
  ds_read_b128 v[40:43], v202 offset:19456
  ds_read_b128 v[44:47], v202 offset:20480
  s_waitcnt lgkmcnt(8)
  v_add_f32 v0, v0, v12
  v_add_f32 v1, v1, v13
  v_add_f32 v2, v2, v14
  v_add_f32 v3, v3, v15
  s_waitcnt lgkmcnt(7)
  v_add_f32 v4, v4, v16
  v_add_f32 v5, v5, v17
  v_add_f32 v6, v6, v18
  v_add_f32 v7, v7, v19
  s_waitcnt lgkmcnt(6)
  v_add_f32 v8, v8, v20
  v_add_f32 v9, v9, v21
  v_add_f32 v10, v10, v22
  v_add_f32 v11, v11, v23
  s_waitcnt lgkmcnt(5)
  v_add_f32 v0, v0, v24
  v_add_f32 v1, v1, v25
  v_add_f32 v2, v2, v26
  v_add_f32 v3, v3, v27
  s_waitcnt lgkmcnt(4)
  v_add_f32 v4, v4, v28
  v_add_f32 v5, v5, v29
  v_add_f32 v6, v6, v30
  v_add_f32 v7, v7, v31
  s_waitcnt lgkmcnt(3)
  v_add_f32 v8, v8, v32
  v_add_f32 v9, v9, v33
  v_add_f32 v10, v10, v34
  v_add_f32 v11, v11, v35
  s_waitcnt lgkmcnt(2)
  v_add_f32 v0, v0, v36
  v_add_f32 v1, v1, v37
  v_add_f32 v2, v2, v38
  v_add_f32 v3, v3, v39
  s_waitcnt lgkmcnt(1)
  v_add_f32 v4, v4, v40
  v_add_f32 v5, v5, v41
  v_add_f32 v6, v6, v42
  v_add_f32 v7, v7, v43
  s_waitcnt lgkmcnt(0)
  v_add_f32 v8, v8, v44
  v_add_f32 v9, v9, v45
  v_add_f32 v10, v10, v46
  v_add_f32 v11, v11, v47
  v_lshrrev_b32 v204, 5, v200
  v_lshlrev_b32 v204, 2, v204
  v_subrev_u32 v204, s34, v204
  v_add_u32 v205, 0, v204
  v_cmp_gt_u32 vcc, 18, v205
  s_nop 1
  v_cndmask_b32 v0, 0, v0, vcc
  v_add_u32 v205, 1, v204
  v_cmp_gt_u32 vcc, 18, v205
  s_nop 1
  v_cndmask_b32 v1, 0, v1, vcc
  v_add_u32 v205, 2, v204
  v_cmp_gt_u32 vcc, 18, v205
  s_nop 1
  v_cndmask_b32 v2, 0, v2, vcc
  v_add_u32 v205, 3, v204
  v_cmp_gt_u32 vcc, 18, v205
  s_nop 1
  v_cndmask_b32 v3, 0, v3, vcc
  v_add_u32 v205, 8, v204
  v_cmp_gt_u32 vcc, 18, v205
  s_nop 1
  v_cndmask_b32 v4, 0, v4, vcc
  v_add_u32 v205, 9, v204
  v_cmp_gt_u32 vcc, 18, v205
  s_nop 1
  v_cndmask_b32 v5, 0, v5, vcc
  v_add_u32 v205, 10, v204
  v_cmp_gt_u32 vcc, 18, v205
  s_nop 1
  v_cndmask_b32 v6, 0, v6, vcc
  v_add_u32 v205, 11, v204
  v_cmp_gt_u32 vcc, 18, v205
  s_nop 1
  v_cndmask_b32 v7, 0, v7, vcc
  v_add_u32 v205, 16, v204
  v_cmp_gt_u32 vcc, 18, v205
  s_nop 1
  v_cndmask_b32 v8, 0, v8, vcc
  v_add_u32 v205, 17, v204
  v_cmp_gt_u32 vcc, 18, v205
  s_nop 1
  v_cndmask_b32 v9, 0, v9, vcc
  v_add_u32 v205, 18, v204
  v_cmp_gt_u32 vcc, 18, v205
  s_nop 1
  v_cndmask_b32 v10, 0, v10, vcc
  v_add_u32 v205, 19, v204
  v_cmp_gt_u32 vcc, 18, v205
  s_nop 1
  v_cndmask_b32 v11, 0, v11, vcc
  v_cvt_pk_bf16_f32 v184, v0, v1
  v_cvt_pk_bf16_f32 v185, v2, v3
  v_cvt_pk_bf16_f32 v186, v4, v5
  v_cvt_pk_bf16_f32 v187, v6, v7
  v_cvt_pk_bf16_f32 v188, v8, v9
  v_cvt_pk_bf16_f32 v189, v10, v11
  v_mov_b32 v190, 0
  v_mov_b32 v191, 0
  s_waitcnt vmcnt(7)
  v_mfma_f32_32x32x16_bf16 v[150:165], v[184:187], v[100:103], 0
  s_waitcnt vmcnt(6)
  v_mfma_f32_32x32x16_bf16 v[150:165], v[188:191], v[104:107], v[150:165]
  s_nop 11
  v_cvt_pk_bf16_f32 v204, v160, v160
  v_lshlrev_b32 v204, 16, v204
  v_add_f32 v204, 0x358637bd, v204
  v_cvt_pk_bf16_f32 v204, v204, v204
  v_lshlrev_b32 v204, 16, v204
  v_rcp_f32 v204, v204
  v_cvt_pk_bf16_f32 v170, v150, v151
  v_cvt_pk_bf16_f32 v171, v152, v153
  v_cvt_pk_bf16_f32 v172, v154, v155
  v_cvt_pk_bf16_f32 v173, v156, v157
  v_cvt_pk_bf16_f32 v174, v158, v159
  v_lshlrev_b32 v150, 16, v170
  v_and_b32 v151, 0xffff0000, v170
  v_lshlrev_b32 v152, 16, v171
  v_and_b32 v153, 0xffff0000, v171
  v_lshlrev_b32 v154, 16, v172
  v_and_b32 v155, 0xffff0000, v172
  v_lshlrev_b32 v156, 16, v173
  v_and_b32 v157, 0xffff0000, v173
  v_lshlrev_b32 v158, 16, v174
  v_and_b32 v159, 0xffff0000, v174
  v_mul_f32 v150, v150, v204
  v_mul_f32 v151, v151, v204
  v_mul_f32 v152, v152, v204
  v_mul_f32 v153, v153, v204
  v_mul_f32 v154, v154, v204
  v_mul_f32 v155, v155, v204
  v_mul_f32 v156, v156, v204
  v_mul_f32 v157, v157, v204
  v_mul_f32 v158, v158, v204
  v_mul_f32 v159, v159, v204
  v_cvt_pk_bf16_f32 v170, v150, v151
  v_cvt_pk_bf16_f32 v171, v152, v153
  v_cvt_pk_bf16_f32 v172, v154, v155
  v_cvt_pk_bf16_f32 v173, v156, v157
  v_cvt_pk_bf16_f32 v174, v158, v159
  s_add_u32 s40, s38, 0
  s_add_u32 s41, s39, 0
  buffer_store_dwordx4 v[170:173], v208, s[8:11], s40 offen sc0 sc1
  buffer_store_dword v174, v209, s[8:11], s41 offen sc0 sc1
  s_waitcnt vmcnt(7)
  v_mfma_f32_32x32x16_bf16 v[150:165], v[184:187], v[112:115], 0
  s_waitcnt vmcnt(6)
  v_mfma_f32_32x32x16_bf16 v[150:165], v[188:191], v[116:119], v[150:165]
  s_nop 11
  v_cvt_pk_bf16_f32 v204, v160, v160
  v_lshlrev_b32 v204, 16, v204
  v_add_f32 v204, 0x358637bd, v204
  v_cvt_pk_bf16_f32 v204, v204, v204
  v_lshlrev_b32 v204, 16, v204
  v_rcp_f32 v204, v204
  v_cvt_pk_bf16_f32 v170, v150, v151
  v_cvt_pk_bf16_f32 v171, v152, v153
  v_cvt_pk_bf16_f32 v172, v154, v155
  v_cvt_pk_bf16_f32 v173, v156, v157
  v_cvt_pk_bf16_f32 v174, v158, v159
  v_lshlrev_b32 v150, 16, v170
  v_and_b32 v151, 0xffff0000, v170
  v_lshlrev_b32 v152, 16, v171
  v_and_b32 v153, 0xffff0000, v171
  v_lshlrev_b32 v154, 16, v172
  v_and_b32 v155, 0xffff0000, v172
  v_lshlrev_b32 v156, 16, v173
  v_and_b32 v157, 0xffff0000, v173
  v_lshlrev_b32 v158, 16, v174
  v_and_b32 v159, 0xffff0000, v174
  v_mul_f32 v150, v150, v204
  v_mul_f32 v151, v151, v204
  v_mul_f32 v152, v152, v204
  v_mul_f32 v153, v153, v204
  v_mul_f32 v154, v154, v204
  v_mul_f32 v155, v155, v204
  v_mul_f32 v156, v156, v204
  v_mul_f32 v157, v157, v204
  v_mul_f32 v158, v158, v204
  v_mul_f32 v159, v159, v204
  v_cvt_pk_bf16_f32 v170, v150, v151
  v_cvt_pk_bf16_f32 v171, v152, v153
  v_cvt_pk_bf16_f32 v172, v154, v155
  v_cvt_pk_bf16_f32 v173, v156, v157
  v_cvt_pk_bf16_f32 v174, v158, v159
  s_add_u32 s40, s38, 2048
  s_add_u32 s41, s39, 2048
  buffer_store_dwordx4 v[170:173], v208, s[8:11], s40 offen sc0 sc1
  buffer_store_dword v174, v209, s[8:11], s41 offen sc0 sc1
  s_waitcnt vmcnt(7)
  v_mfma_f32_32x32x16_bf16 v[150:165], v[184:187], v[124:127], 0
  s_waitcnt vmcnt(6)
  v_mfma_f32_32x32x16_bf16 v[150:165], v[188:191], v[128:131], v[150:165]
  s_nop 11
  v_cvt_pk_bf16_f32 v204, v160, v160
  v_lshlrev_b32 v204, 16, v204
  v_add_f32 v204, 0x358637bd, v204
  v_cvt_pk_bf16_f32 v204, v204, v204
  v_lshlrev_b32 v204, 16, v204
  v_rcp_f32 v204, v204
  v_cvt_pk_bf16_f32 v170, v150, v151
  v_cvt_pk_bf16_f32 v171, v152, v153
  v_cvt_pk_bf16_f32 v172, v154, v155
  v_cvt_pk_bf16_f32 v173, v156, v157
  v_cvt_pk_bf16_f32 v174, v158, v159
  v_lshlrev_b32 v150, 16, v170
  v_and_b32 v151, 0xffff0000, v170
  v_lshlrev_b32 v152, 16, v171
  v_and_b32 v153, 0xffff0000, v171
  v_lshlrev_b32 v154, 16, v172
  v_and_b32 v155, 0xffff0000, v172
  v_lshlrev_b32 v156, 16, v173
  v_and_b32 v157, 0xffff0000, v173
  v_lshlrev_b32 v158, 16, v174
  v_and_b32 v159, 0xffff0000, v174
  v_mul_f32 v150, v150, v204
  v_mul_f32 v151, v151, v204
  v_mul_f32 v152, v152, v204
  v_mul_f32 v153, v153, v204
  v_mul_f32 v154, v154, v204
  v_mul_f32 v155, v155, v204
  v_mul_f32 v156, v156, v204
  v_mul_f32 v157, v157, v204
  v_mul_f32 v158, v158, v204
  v_mul_f32 v159, v159, v204
  v_cvt_pk_bf16_f32 v170, v150, v151
  v_cvt_pk_bf16_f32 v171, v152, v153
  v_cvt_pk_bf16_f32 v172, v154, v155
  v_cvt_pk_bf16_f32 v173, v156, v157
  v_cvt_pk_bf16_f32 v174, v158, v159
  s_add_u32 s40, s38, 4096
  s_add_u32 s41, s39, 4096
  buffer_store_dwordx4 v[170:173], v208, s[8:11], s40 offen sc0 sc1
  buffer_store_dword v174, v209, s[8:11], s41 offen sc0 sc1
  s_waitcnt vmcnt(7)
  v_mfma_f32_32x32x16_bf16 v[150:165], v[184:187], v[136:139], 0
  s_waitcnt vmcnt(6)
  v_mfma_f32_32x32x16_bf16 v[150:165], v[188:191], v[140:143], v[150:165]
  s_nop 11
  v_cvt_pk_bf16_f32 v204, v160, v160
  v_lshlrev_b32 v204, 16, v204
  v_add_f32 v204, 0x358637bd, v204
  v_cvt_pk_bf16_f32 v204, v204, v204
  v_lshlrev_b32 v204, 16, v204
  v_rcp_f32 v204, v204
  v_cvt_pk_bf16_f32 v170, v150, v151
  v_cvt_pk_bf16_f32 v171, v152, v153
  v_cvt_pk_bf16_f32 v172, v154, v155
  v_cvt_pk_bf16_f32 v173, v156, v157
  v_cvt_pk_bf16_f32 v174, v158, v159
  v_lshlrev_b32 v150, 16, v170
  v_and_b32 v151, 0xffff0000, v170
  v_lshlrev_b32 v152, 16, v171
  v_and_b32 v153, 0xffff0000, v171
  v_lshlrev_b32 v154, 16, v172
  v_and_b32 v155, 0xffff0000, v172
  v_lshlrev_b32 v156, 16, v173
  v_and_b32 v157, 0xffff0000, v173
  v_lshlrev_b32 v158, 16, v174
  v_and_b32 v159, 0xffff0000, v174
  v_mul_f32 v150, v150, v204
  v_mul_f32 v151, v151, v204
  v_mul_f32 v152, v152, v204
  v_mul_f32 v153, v153, v204
  v_mul_f32 v154, v154, v204
  v_mul_f32 v155, v155, v204
  v_mul_f32 v156, v156, v204
  v_mul_f32 v157, v157, v204
  v_mul_f32 v158, v158, v204
  v_mul_f32 v159, v159, v204
  v_cvt_pk_bf16_f32 v170, v150, v151
  v_cvt_pk_bf16_f32 v171, v152, v153
  v_cvt_pk_bf16_f32 v172, v154, v155
  v_cvt_pk_bf16_f32 v173, v156, v157
  v_cvt_pk_bf16_f32 v174, v158, v159
  s_add_u32 s40, s38, 6144
  s_add_u32 s41, s39, 6144
  buffer_store_dwordx4 v[170:173], v208, s[8:11], s40 offen sc0 sc1
  buffer_store_dword v174, v209, s[8:11], s41 offen sc0 sc1
  s_endpgm
k2a_b:
  s_waitcnt vmcnt(0)
  s_nop 15
  s_nop 7
  s_lshl_b32 s33, s32, 1
  s_add_u32 s33, s33, 32
  v_lshlrev_b32 v202, 4, v200
  s_lshl_b32 s40, s24, 2
  s_add_u32 s40, s40, 0
  s_mul_i32 s40, s40, 96
  s_add_u32 s40, s40, s33
  s_add_u32 s40, s40, 0
  s_mul_i32 s40, s40, 3072
  s_add_u32 s40, s40, 7340032
  buffer_load_dwordx4 v[0:3], v202, s[8:11], s40 offen offset:0
  buffer_load_dwordx4 v[4:7], v202, s[8:11], s40 offen offset:1024
  buffer_load_dwordx4 v[8:11], v202, s[8:11], s40 offen offset:2048
  s_lshl_b32 s40, s24, 2
  s_add_u32 s40, s40, 1
  s_mul_i32 s40, s40, 96
  s_add_u32 s40, s40, s33
  s_add_u32 s40, s40, 0
  s_mul_i32 s40, s40, 3072
  s_add_u32 s40, s40, 7340032
  buffer_load_dwordx4 v[12:15], v202, s[8:11], s40 offen offset:0
  buffer_load_dwordx4 v[16:19], v202, s[8:11], s40 offen offset:1024
  buffer_load_dwordx4 v[20:23], v202, s[8:11], s40 offen offset:2048
  s_lshl_b32 s40, s24, 2
  s_add_u32 s40, s40, 2
  s_mul_i32 s40, s40, 96
  s_add_u32 s40, s40, s33
  s_add_u32 s40, s40, 0
  s_mul_i32 s40, s40, 3072
  s_add_u32 s40, s40, 7340032
  buffer_load_dwordx4 v[24:27], v202, s[8:11], s40 offen offset:0
  buffer_load_dwordx4 v[28:31], v202, s[8:11], s40 offen offset:1024
  buffer_load_dwordx4 v[32:35], v202, s[8:11], s40 offen offset:2048
  s_lshl_b32 s40, s24, 2
  s_add_u32 s40, s40, 3
  s_mul_i32 s40, s40, 96
  s_add_u32 s40, s40, s33
  s_add_u32 s40, s40, 0
  s_mul_i32 s40, s40, 3072
  s_add_u32 s40, s40, 7340032
  buffer_load_dwordx4 v[36:39], v202, s[8:11], s40 offen offset:0
  buffer_load_dwordx4 v[40:43], v202, s[8:11], s40 offen offset:1024
  buffer_load_dwordx4 v[44:47], v202, s[8:11], s40 offen offset:2048
  s_lshl_b32 s40, s24, 2
  s_add_u32 s40, s40, 0
  s_mul_i32 s40, s40, 96
  s_add_u32 s40, s40, s33
  s_add_u32 s40, s40, 1
  s_mul_i32 s40, s40, 3072
  s_add_u32 s40, s40, 7340032
  buffer_load_dwordx4 v[48:51], v202, s[8:11], s40 offen offset:0
  buffer_load_dwordx4 v[52:55], v202, s[8:11], s40 offen offset:1024
  buffer_load_dwordx4 v[56:59], v202, s[8:11], s40 offen offset:2048
  s_lshl_b32 s40, s24, 2
  s_add_u32 s40, s40, 1
  s_mul_i32 s40, s40, 96
  s_add_u32 s40, s40, s33
  s_add_u32 s40, s40, 1
  s_mul_i32 s40, s40, 3072
  s_add_u32 s40, s40, 7340032
  buffer_load_dwordx4 v[60:63], v202, s[8:11], s40 offen offset:0
  buffer_load_dwordx4 v[64:67], v202, s[8:11], s40 offen offset:1024
  buffer_load_dwordx4 v[68:71], v202, s[8:11], s40 offen offset:2048
  s_lshl_b32 s40, s24, 2
  s_add_u32 s40, s40, 2
  s_mul_i32 s40, s40, 96
  s_add_u32 s40, s40, s33
  s_add_u32 s40, s40, 1
  s_mul_i32 s40, s40, 3072
  s_add_u32 s40, s40, 7340032
  buffer_load_dwordx4 v[72:75], v202, s[8:11], s40 offen offset:0
  buffer_load_dwordx4 v[76:79], v202, s[8:11], s40 offen offset:1024
  buffer_load_dwordx4 v[80:83], v202, s[8:11], s40 offen offset:2048
  s_lshl_b32 s40, s24, 2
  s_add_u32 s40, s40, 3
  s_mul_i32 s40, s40, 96
  s_add_u32 s40, s40, s33
  s_add_u32 s40, s40, 1
  s_mul_i32 s40, s40, 3072
  s_add_u32 s40, s40, 7340032
  buffer_load_dwordx4 v[84:87], v202, s[8:11], s40 offen offset:0
  buffer_load_dwordx4 v[88:91], v202, s[8:11], s40 offen offset:1024
  buffer_load_dwordx4 v[92:95], v202, s[8:11], s40 offen offset:2048
  s_add_u32 s40, s35, 0
  s_lshl_b32 s40, s40, 5
  s_add_u32 s40, s40, s32
  s_lshl_b32 s41, s40, 11
  s_add_u32 s41, s41, 2621440
  s_lshl_b32 s42, s40, 8
  s_add_u32 s42, s42, 6815744
  buffer_load_dwordx4 v[100:103], v202, s[8:11], s41 offen offset:0
  buffer_load_dwordx4 v[104:107], v202, s[8:11], s41 offen offset:1024
  buffer_load_dword v108, v210, s[8:11], s42 offen
  v_mov_b32 v109, 0
  v_mov_b32 v110, 0
  v_mov_b32 v111, 0
  s_add_u32 s40, s35, 1
  s_lshl_b32 s40, s40, 5
  s_add_u32 s40, s40, s32
  s_lshl_b32 s41, s40, 11
  s_add_u32 s41, s41, 2621440
  s_lshl_b32 s42, s40, 8
  s_add_u32 s42, s42, 6815744
  buffer_load_dwordx4 v[112:115], v202, s[8:11], s41 offen offset:0
  buffer_load_dwordx4 v[116:119], v202, s[8:11], s41 offen offset:1024
  buffer_load_dword v120, v210, s[8:11], s42 offen
  v_mov_b32 v121, 0
  v_mov_b32 v122, 0
  v_mov_b32 v123, 0
  s_add_u32 s40, s35, 2
  s_lshl_b32 s40, s40, 5
  s_add_u32 s40, s40, s32
  s_lshl_b32 s41, s40, 11
  s_add_u32 s41, s41, 2621440
  s_lshl_b32 s42, s40, 8
  s_add_u32 s42, s42, 6815744
  buffer_load_dwordx4 v[124:127], v202, s[8:11], s41 offen offset:0
  buffer_load_dwordx4 v[128:131], v202, s[8:11], s41 offen offset:1024
  buffer_load_dword v132, v210, s[8:11], s42 offen
  v_mov_b32 v133, 0
  v_mov_b32 v134, 0
  v_mov_b32 v135, 0
  s_add_u32 s40, s35, 3
  s_lshl_b32 s40, s40, 5
  s_add_u32 s40, s40, s32
  s_lshl_b32 s41, s40, 11
  s_add_u32 s41, s41, 2621440
  s_lshl_b32 s42, s40, 8
  s_add_u32 s42, s42, 6815744
  buffer_load_dwordx4 v[136:139], v202, s[8:11], s41 offen offset:0
  buffer_load_dwordx4 v[140:143], v202, s[8:11], s41 offen offset:1024
  buffer_load_dword v144, v210, s[8:11], s42 offen
  v_mov_b32 v145, 0
  v_mov_b32 v146, 0
  v_mov_b32 v147, 0
  s_waitcnt vmcnt(32)
  v_add_f32 v0, v0, v12
  s_waitcnt vmcnt(26)
  v_add_f32 v24, v24, v36
  v_add_f32 v1, v1, v13
  v_add_f32 v25, v25, v37
  v_add_f32 v2, v2, v14
  v_add_f32 v26, v26, v38
  v_add_f32 v3, v3, v15
  v_add_f32 v27, v27, v39
  v_add_f32 v4, v4, v16
  s_waitcnt vmcnt(25)
  v_add_f32 v28, v28, v40
  v_add_f32 v5, v5, v17
  v_add_f32 v29, v29, v41
  v_add_f32 v6, v6, v18
  v_add_f32 v30, v30, v42
  v_add_f32 v7, v7, v19
  v_add_f32 v31, v31, v43
  v_add_f32 v8, v8, v20
  s_waitcnt vmcnt(24)
  v_add_f32 v32, v32, v44
  v_add_f32 v9, v9, v21
  v_add_f32 v33, v33, v45
  v_add_f32 v10, v10, v22
  v_add_f32 v34, v34, v46
  v_add_f32 v11, v11, v23
  v_add_f32 v35, v35, v47
  v_add_f32 v0, v0, v24
  v_add_f32 v1, v1, v25
  v_add_f32 v2, v2, v26
  v_add_f32 v3, v3, v27
  v_add_f32 v4, v4, v28
  v_add_f32 v5, v5, v29
  v_add_f32 v6, v6, v30
  v_add_f32 v7, v7, v31
  v_add_f32 v8, v8, v32
  v_add_f32 v9, v9, v33
  v_add_f32 v10, v10, v34
  v_add_f32 v11, v11, v35
  s_waitcnt vmcnt(20)
  v_add_f32 v48, v48, v60
  s_waitcnt vmcnt(14)
  v_add_f32 v72, v72, v84
  v_add_f32 v49, v49, v61
  v_add_f32 v73, v73, v85
  v_add_f32 v50, v50, v62
  v_add_f32 v74, v74, v86
  v_add_f32 v51, v51, v63
  v_add_f32 v75, v75, v87
  v_add_f32 v52, v52, v64
  s_waitcnt vmcnt(13)
  v_add_f32 v76, v76, v88
  v_add_f32 v53, v53, v65
  v_add_f32 v77, v77, v89
  v_add_f32 v54, v54, v66
  v_add_f32 v78, v78, v90
  v_add_f32 v55, v55, v67
  v_add_f32 v79, v79, v91
  v_add_f32 v56, v56, v68
  s_waitcnt vmcnt(12)
  v_add_f32 v80, v80, v92
  v_add_f32 v57, v57, v69
  v_add_f32 v81, v81, v93
  v_add_f32 v58, v58, v70
  v_add_f32 v82, v82, v94
  v_add_f32 v59, v59, v71
  v_add_f32 v83, v83, v95
  v_add_f32 v48, v48, v72
  v_add_f32 v49, v49, v73
  v_add_f32 v50, v50, v74
  v_add_f32 v51, v51, v75
  v_add_f32 v52, v52, v76
  v_add_f32 v53, v53, v77
  v_add_f32 v54, v54, v78
  v_add_f32 v55, v55, v79
  v_add_f32 v56, v56, v80
  v_add_f32 v57, v57, v81
  v_add_f32 v58, v58, v82
  v_add_f32 v59, v59, v83
  s_mul_i32 s40, s24, 6144
  v_add_u32 v203, s40, v202
  ds_write_b128 v203, v[0:3] offset:0
  ds_write_b128 v203, v[4:7] offset:1024
  ds_write_b128 v203, v[8:11] offset:2048
  ds_write_b128 v203, v[48:51] offset:3072
  ds_write_b128 v203, v[52:55] offset:4096
  ds_write_b128 v203, v[56:59] offset:5120
  s_waitcnt lgkmcnt(0)
  s_barrier
  ds_read_b128 v[0:3], v202 offset:0
  ds_read_b128 v[4:7], v202 offset:1024
  ds_read_b128 v[8:11], v202 offset:2048
  ds_read_b128 v[12:15], v202 offset:6144
  ds_read_b128 v[16:19], v202 offset:7168
  ds_read_b128 v[20:23], v202 offset:8192
  ds_read_b128 v[24:27], v202 offset:12288
  ds_read_b128 v[28:31], v202 offset:13312
  ds_read_b128 v[32:35], v202 offset:14336
  ds_read_b128 v[36:39], v202 offset:18432
  ds_read_b128 v[40:43], v202 offset:19456
  ds_read_b128 v[44:47], v202 offset:20480
  s_waitcnt lgkmcnt(8)
  v_add_f32 v0, v0, v12
  v_add_f32 v1, v1, v13
  v_add_f32 v2, v2, v14
  v_add_f32 v3, v3, v15
  s_waitcnt lgkmcnt(7)
  v_add_f32 v4, v4, v16
  v_add_f32 v5, v5, v17
  v_add_f32 v6, v6, v18
  v_add_f32 v7, v7, v19
  s_waitcnt lgkmcnt(6)
  v_add_f32 v8, v8, v20
  v_add_f32 v9, v9, v21
  v_add_f32 v10, v10, v22
  v_add_f32 v11, v11, v23
  s_waitcnt lgkmcnt(5)
  v_add_f32 v0, v0, v24
  v_add_f32 v1, v1, v25
  v_add_f32 v2, v2, v26
  v_add_f32 v3, v3, v27
  s_waitcnt lgkmcnt(4)
  v_add_f32 v4, v4, v28
  v_add_f32 v5, v5, v29
  v_add_f32 v6, v6, v30
  v_add_f32 v7, v7, v31
  s_waitcnt lgkmcnt(3)
  v_add_f32 v8, v8, v32
  v_add_f32 v9, v9, v33
  v_add_f32 v10, v10, v34
  v_add_f32 v11, v11, v35
  s_waitcnt lgkmcnt(2)
  v_add_f32 v0, v0, v36
  v_add_f32 v1, v1, v37
  v_add_f32 v2, v2, v38
  v_add_f32 v3, v3, v39
  s_waitcnt lgkmcnt(1)
  v_add_f32 v4, v4, v40
  v_add_f32 v5, v5, v41
  v_add_f32 v6, v6, v42
  v_add_f32 v7, v7, v43
  s_waitcnt lgkmcnt(0)
  v_add_f32 v8, v8, v44
  v_add_f32 v9, v9, v45
  v_add_f32 v10, v10, v46
  v_add_f32 v11, v11, v47
  ds_read_b128 v[48:51], v202 offset:3072
  ds_read_b128 v[52:55], v202 offset:4096
  ds_read_b128 v[56:59], v202 offset:5120
  ds_read_b128 v[60:63], v202 offset:9216
  ds_read_b128 v[64:67], v202 offset:10240
  ds_read_b128 v[68:71], v202 offset:11264
  ds_read_b128 v[72:75], v202 offset:15360
  ds_read_b128 v[76:79], v202 offset:16384
  ds_read_b128 v[80:83], v202 offset:17408
  ds_read_b128 v[84:87], v202 offset:21504
  ds_read_b128 v[88:91], v202 offset:22528
  ds_read_b128 v[92:95], v202 offset:23552
  s_waitcnt lgkmcnt(8)
  v_add_f32 v48, v48, v60
  v_add_f32 v49, v49, v61
  v_add_f32 v50, v50, v62
  v_add_f32 v51, v51, v63
  s_waitcnt lgkmcnt(7)
  v_add_f32 v52, v52, v64
  v_add_f32 v53, v53, v65
  v_add_f32 v54, v54, v66
  v_add_f32 v55, v55, v67
  s_waitcnt lgkmcnt(6)
  v_add_f32 v56, v56, v68
  v_add_f32 v57, v57, v69
  v_add_f32 v58, v58, v70
  v_add_f32 v59, v59, v71
  s_waitcnt lgkmcnt(5)
  v_add_f32 v48, v48, v72
  v_add_f32 v49, v49, v73
  v_add_f32 v50, v50, v74
  v_add_f32 v51, v51, v75
  s_waitcnt lgkmcnt(4)
  v_add_f32 v52, v52, v76
  v_add_f32 v53, v53, v77
  v_add_f32 v54, v54, v78
  v_add_f32 v55, v55, v79
  s_waitcnt lgkmcnt(3)
  v_add_f32 v56, v56, v80
  v_add_f32 v57, v57, v81
  v_add_f32 v58, v58, v82
  v_add_f32 v59, v59, v83
  s_waitcnt lgkmcnt(2)
  v_add_f32 v48, v48, v84
  v_add_f32 v49, v49, v85
  v_add_f32 v50, v50, v86
  v_add_f32 v51, v51, v87
  s_waitcnt lgkmcnt(1)
  v_add_f32 v52, v52, v88
  v_add_f32 v53, v53, v89
  v_add_f32 v54, v54, v90
  v_add_f32 v55, v55, v91
  s_waitcnt lgkmcnt(0)
  v_add_f32 v56, v56, v92
  v_add_f32 v57, v57, v93
  v_add_f32 v58, v58, v94
  v_add_f32 v59, v59, v95
  v_cvt_pk_bf16_f32 v184, v0, v1
  v_cvt_pk_bf16_f32 v185, v2, v3
  v_cvt_pk_bf16_f32 v186, v4, v5
  v_cvt_pk_bf16_f32 v187, v6, v7
  v_cvt_pk_bf16_f32 v188, v48, v49
  v_cvt_pk_bf16_f32 v189, v50, v51
  v_cvt_pk_bf16_f32 v190, v52, v53
  v_cvt_pk_bf16_f32 v191, v54, v55
  v_cvt_pk_bf16_f32 v192, v8, v56
  v_mov_b32 v193, 0
  v_mov_b32 v194, 0
  v_mov_b32 v195, 0
  s_waitcnt vmcnt(11)
  v_mfma_f32_32x32x16_bf16 v[150:165], v[184:187], v[100:103], 0
  s_waitcnt vmcnt(10)
  v_mfma_f32_32x32x16_bf16 v[150:165], v[188:191], v[104:107], v[150:165]
  s_waitcnt vmcnt(9)
  v_mfma_f32_32x32x16_bf16 v[150:165], v[192:195], v[108:111], v[150:165]
  s_nop 11
  v_cvt_pk_bf16_f32 v204, v160, v160
  v_lshlrev_b32 v204, 16, v204
  v_add_f32 v204, 0x358637bd, v204
  v_cvt_pk_bf16_f32 v204, v204, v204
  v_lshlrev_b32 v204, 16, v204
  v_rcp_f32 v204, v204
  v_cvt_pk_bf16_f32 v170, v150, v151
  v_cvt_pk_bf16_f32 v171, v152, v153
  v_cvt_pk_bf16_f32 v172, v154, v155
  v_cvt_pk_bf16_f32 v173, v156, v157
  v_cvt_pk_bf16_f32 v174, v158, v159
  v_lshlrev_b32 v150, 16, v170
  v_and_b32 v151, 0xffff0000, v170
  v_lshlrev_b32 v152, 16, v171
  v_and_b32 v153, 0xffff0000, v171
  v_lshlrev_b32 v154, 16, v172
  v_and_b32 v155, 0xffff0000, v172
  v_lshlrev_b32 v156, 16, v173
  v_and_b32 v157, 0xffff0000, v173
  v_lshlrev_b32 v158, 16, v174
  v_and_b32 v159, 0xffff0000, v174
  v_mul_f32 v150, v150, v204
  v_mul_f32 v151, v151, v204
  v_mul_f32 v152, v152, v204
  v_mul_f32 v153, v153, v204
  v_mul_f32 v154, v154, v204
  v_mul_f32 v155, v155, v204
  v_mul_f32 v156, v156, v204
  v_mul_f32 v157, v157, v204
  v_mul_f32 v158, v158, v204
  v_mul_f32 v159, v159, v204
  v_cvt_pk_bf16_f32 v170, v150, v151
  v_cvt_pk_bf16_f32 v171, v152, v153
  v_cvt_pk_bf16_f32 v172, v154, v155
  v_cvt_pk_bf16_f32 v173, v156, v157
  v_cvt_pk_bf16_f32 v174, v158, v159
  s_add_u32 s40, s38, 0
  s_add_u32 s41, s39, 0
  buffer_store_dwordx4 v[170:173], v208, s[8:11], s40 offen sc0 sc1
  buffer_store_dword v174, v209, s[8:11], s41 offen sc0 sc1
  s_waitcnt vmcnt(10)
  v_mfma_f32_32x32x16_bf16 v[150:165], v[184:187], v[112:115], 0
  s_waitcnt vmcnt(9)
  v_mfma_f32_32x32x16_bf16 v[150:165], v[188:191], v[116:119], v[150:165]
  s_waitcnt vmcnt(8)
  v_mfma_f32_32x32x16_bf16 v[150:165], v[192:195], v[120:123], v[150:165]
  s_nop 11
  v_cvt_pk_bf16_f32 v204, v160, v160
  v_lshlrev_b32 v204, 16, v204
  v_add_f32 v204, 0x358637bd, v204
  v_cvt_pk_bf16_f32 v204, v204, v204
  v_lshlrev_b32 v204, 16, v204
  v_rcp_f32 v204, v204
  v_cvt_pk_bf16_f32 v170, v150, v151
  v_cvt_pk_bf16_f32 v171, v152, v153
  v_cvt_pk_bf16_f32 v172, v154, v155
  v_cvt_pk_bf16_f32 v173, v156, v157
  v_cvt_pk_bf16_f32 v174, v158, v159
  v_lshlrev_b32 v150, 16, v170
  v_and_b32 v151, 0xffff0000, v170
  v_lshlrev_b32 v152, 16, v171
  v_and_b32 v153, 0xffff0000, v171
  v_lshlrev_b32 v154, 16, v172
  v_and_b32 v155, 0xffff0000, v172
  v_lshlrev_b32 v156, 16, v173
  v_and_b32 v157, 0xffff0000, v173
  v_lshlrev_b32 v158, 16, v174
  v_and_b32 v159, 0xffff0000, v174
  v_mul_f32 v150, v150, v204
  v_mul_f32 v151, v151, v204
  v_mul_f32 v152, v152, v204
  v_mul_f32 v153, v153, v204
  v_mul_f32 v154, v154, v204
  v_mul_f32 v155, v155, v204
  v_mul_f32 v156, v156, v204
  v_mul_f32 v157, v157, v204
  v_mul_f32 v158, v158, v204
  v_mul_f32 v159, v159, v204
  v_cvt_pk_bf16_f32 v170, v150, v151
  v_cvt_pk_bf16_f32 v171, v152, v153
  v_cvt_pk_bf16_f32 v172, v154, v155
  v_cvt_pk_bf16_f32 v173, v156, v157
  v_cvt_pk_bf16_f32 v174, v158, v159
  s_add_u32 s40, s38, 2048
  s_add_u32 s41, s39, 2048
  buffer_store_dwordx4 v[170:173], v208, s[8:11], s40 offen sc0 sc1
  buffer_store_dword v174, v209, s[8:11], s41 offen sc0 sc1
  s_waitcnt vmcnt(9)
  v_mfma_f32_32x32x16_bf16 v[150:165], v[184:187], v[124:127], 0
  s_waitcnt vmcnt(8)
  v_mfma_f32_32x32x16_bf16 v[150:165], v[188:191], v[128:131], v[150:165]
  s_waitcnt vmcnt(7)
  v_mfma_f32_32x32x16_bf16 v[150:165], v[192:195], v[132:135], v[150:165]
  s_nop 11
  v_cvt_pk_bf16_f32 v204, v160, v160
  v_lshlrev_b32 v204, 16, v204
  v_add_f32 v204, 0x358637bd, v204
  v_cvt_pk_bf16_f32 v204, v204, v204
  v_lshlrev_b32 v204, 16, v204
  v_rcp_f32 v204, v204
  v_cvt_pk_bf16_f32 v170, v150, v151
  v_cvt_pk_bf16_f32 v171, v152, v153
  v_cvt_pk_bf16_f32 v172, v154, v155
  v_cvt_pk_bf16_f32 v173, v156, v157
  v_cvt_pk_bf16_f32 v174, v158, v159
  v_lshlrev_b32 v150, 16, v170
  v_and_b32 v151, 0xffff0000, v170
  v_lshlrev_b32 v152, 16, v171
  v_and_b32 v153, 0xffff0000, v171
  v_lshlrev_b32 v154, 16, v172
  v_and_b32 v155, 0xffff0000, v172
  v_lshlrev_b32 v156, 16, v173
  v_and_b32 v157, 0xffff0000, v173
  v_lshlrev_b32 v158, 16, v174
  v_and_b32 v159, 0xffff0000, v174
  v_mul_f32 v150, v150, v204
  v_mul_f32 v151, v151, v204
  v_mul_f32 v152, v152, v204
  v_mul_f32 v153, v153, v204
  v_mul_f32 v154, v154, v204
  v_mul_f32 v155, v155, v204
  v_mul_f32 v156, v156, v204
  v_mul_f32 v157, v157, v204
  v_mul_f32 v158, v158, v204
  v_mul_f32 v159, v159, v204
  v_cvt_pk_bf16_f32 v170, v150, v151
  v_cvt_pk_bf16_f32 v171, v152, v153
  v_cvt_pk_bf16_f32 v172, v154, v155
  v_cvt_pk_bf16_f32 v173, v156, v157
  v_cvt_pk_bf16_f32 v174, v158, v159
  s_add_u32 s40, s38, 4096
  s_add_u32 s41, s39, 4096
  buffer_store_dwordx4 v[170:173], v208, s[8:11], s40 offen sc0 sc1
  buffer_store_dword v174, v209, s[8:11], s41 offen sc0 sc1
  s_waitcnt vmcnt(8)
  v_mfma_f32_32x32x16_bf16 v[150:165], v[184:187], v[136:139], 0
  s_waitcnt vmcnt(7)
  v_mfma_f32_32x32x16_bf16 v[150:165], v[188:191], v[140:143], v[150:165]
  s_waitcnt vmcnt(6)
  v_mfma_f32_32x32x16_bf16 v[150:165], v[192:195], v[144:147], v[150:165]
  s_nop 11
  v_cvt_pk_bf16_f32 v204, v160, v160
  v_lshlrev_b32 v204, 16, v204
  v_add_f32 v204, 0x358637bd, v204
  v_cvt_pk_bf16_f32 v204, v204, v204
  v_lshlrev_b32 v204, 16, v204
  v_rcp_f32 v204, v204
  v_cvt_pk_bf16_f32 v170, v150, v151
  v_cvt_pk_bf16_f32 v171, v152, v153
  v_cvt_pk_bf16_f32 v172, v154, v155
  v_cvt_pk_bf16_f32 v173, v156, v157
  v_cvt_pk_bf16_f32 v174, v158, v159
  v_lshlrev_b32 v150, 16, v170
  v_and_b32 v151, 0xffff0000, v170
  v_lshlrev_b32 v152, 16, v171
  v_and_b32 v153, 0xffff0000, v171
  v_lshlrev_b32 v154, 16, v172
  v_and_b32 v155, 0xffff0000, v172
  v_lshlrev_b32 v156, 16, v173
  v_and_b32 v157, 0xffff0000, v173
  v_lshlrev_b32 v158, 16, v174
  v_and_b32 v159, 0xffff0000, v174
  v_mul_f32 v150, v150, v204
  v_mul_f32 v151, v151, v204
  v_mul_f32 v152, v152, v204
  v_mul_f32 v153, v153, v204
  v_mul_f32 v154, v154, v204
  v_mul_f32 v155, v155, v204
  v_mul_f32 v156, v156, v204
  v_mul_f32 v157, v157, v204
  v_mul_f32 v158, v158, v204
  v_mul_f32 v159, v159, v204
  v_cvt_pk_bf16_f32 v170, v150, v151
  v_cvt_pk_bf16_f32 v171, v152, v153
  v_cvt_pk_bf16_f32 v172, v154, v155
  v_cvt_pk_bf16_f32 v173, v156, v157
  v_cvt_pk_bf16_f32 v174, v158, v159
  s_add_u32 s40, s38, 6144
  s_add_u32 s41, s39, 6144
  buffer_store_dwordx4 v[170:173], v208, s[8:11], s40 offen sc0 sc1
  buffer_store_dword v174, v209, s[8:11], s41 offen sc0 sc1
  s_endpgm
k2a_end:
  s_waitcnt vmcnt(0)
  s_nop 15
  s_nop 7
  s_endpgm
.globl k2b_kernel
.p2align 8
.type k2b_kernel,@function
k2b_kernel:
  s_cmp_ge_u32 s2, 256
  s_cbranch_scc1 k2b_end
  s_load_dwordx2 s[4:5], s[0:1], 80
  s_load_dwordx2 s[6:7], s[0:1], 64
  v_lshrrev_b32 v194, 6, v0
  v_and_b32 v195, 63, v0
  v_readfirstlane_b32 s16, v194
  s_waitcnt lgkmcnt(0)
  s_mov_b32 s8, s4
  s_and_b32 s9, s5, 0xffff
  s_mov_b32 s10, 0x10000000
  s_mov_b32 s11, 0x20000
  s_mov_b32 s12, s6
  s_and_b32 s13, s7, 0xffff
  s_mov_b32 s14, 0x240000
  s_mov_b32 s15, 0x20000
  s_and_b32 s17, s2, 31
  s_lshr_b32 s18, s2, 5
  s_lshr_b32 s19, s16, 1
  s_and_b32 s20, s16, 1
  s_lshl_b32 s21, s19, 3
  s_add_u32 s21, s21, s18
  s_mul_i32 s21, s21, 18
  s_mul_i32 s22, s20, 9
  s_add_u32 s21, s21, s22
  s_mul_i32 s21, s21, 5120
  s_add_u32 s21, s21, 16777216
  s_mul_i32 s23, s19, 18
  s_mul_i32 s22, s20, 9
  s_add_u32 s23, s23, s22
  s_lshl_b32 s23, s23, 7
  s_lshl_b32 s22, s17, 2
  s_add_u32 s23, s23, s22
  s_lshl_b32 s23, s23, 10
  s_add_u32 s23, s23, 12058624
  v_lshlrev_b32 v188, 4, v195
  v_and_b32 v196, 15, v195
  v_lshrrev_b32 v197, 4, v195
  v_mov_b32 v0, 0
  v_mov_b32 v1, 0
  v_mov_b32 v2, 0
  v_mov_b32 v3, 0
  v_mov_b32 v4, 0
  v_mov_b32 v5, 0
  v_mov_b32 v6, 0
  v_mov_b32 v7, 0
  v_mov_b32 v8, 0
  v_mov_b32 v9, 0
  v_mov_b32 v10, 0
  v_mov_b32 v11, 0
  v_mov_b32 v12, 0
  v_mov_b32 v13, 0
  v_mov_b32 v14, 0
  v_mov_b32 v15, 0
  v_mov_b32 v16, 0
  v_mov_b32 v17, 0
  v_mov_b32 v18, 0
  v_mov_b32 v19, 0
  v_mov_b32 v20, 0
  v_mov_b32 v21, 0
  v_mov_b32 v22, 0
  v_mov_b32 v23, 0
  v_mov_b32 v24, 0
  v_mov_b32 v25, 0
  v_mov_b32 v26, 0
  v_mov_b32 v27, 0
  v_mov_b32 v28, 0
  v_mov_b32 v29, 0
  v_mov_b32 v30, 0
  v_mov_b32 v31, 0
  v_mov_b32 v32, 0
  v_mov_b32 v33, 0
  v_mov_b32 v34, 0
  v_mov_b32 v35, 0
  v_mov_b32 v36, 0
  v_mov_b32 v37, 0
  v_mov_b32 v38, 0
  v_mov_b32 v39, 0
  v_mov_b32 v40, 0
  v_mov_b32 v41, 0
  v_mov_b32 v42, 0
  v_mov_b32 v43, 0
  v_mov_b32 v44, 0
  v_mov_b32 v45, 0
  v_mov_b32 v46, 0
  v_mov_b32 v47, 0
  v_mov_b32 v48, 0
  v_mov_b32 v49, 0
  v_mov_b32 v50, 0
  v_mov_b32 v51, 0
  v_mov_b32 v52, 0
  v_mov_b32 v53, 0
  v_mov_b32 v54, 0
  v_mov_b32 v55, 0
  v_mov_b32 v56, 0
  v_mov_b32 v57, 0
  v_mov_b32 v58, 0
  v_mov_b32 v59, 0
  v_mov_b32 v60, 0
  v_mov_b32 v61, 0
  v_mov_b32 v62, 0
  v_mov_b32 v63, 0
  v_mov_b32 v64, 0
  v_mov_b32 v65, 0
  v_mov_b32 v66, 0
  v_mov_b32 v67, 0
  v_mov_b32 v68, 0
  v_mov_b32 v69, 0
  v_mov_b32 v70, 0
  v_mov_b32 v71, 0
  v_mov_b32 v72, 0
  v_mov_b32 v73, 0
  v_mov_b32 v74, 0
  v_mov_b32 v75, 0
  v_mov_b32 v76, 0
  v_mov_b32 v77, 0
  v_mov_b32 v78, 0
  v_mov_b32 v79, 0
  s_add_u32 s24, s21, 4096
  buffer_load_dwordx4 v[80:83], v188, s[8:11], s21 offen offset:0
  buffer_load_dwordx4 v[84:87], v188, s[8:11], s21 offen offset:1024
  buffer_load_dwordx4 v[88:91], v188, s[8:11], s21 offen offset:2048
  buffer_load_dwordx4 v[92:95], v188, s[8:11], s21 offen offset:3072
  buffer_load_dwordx4 v[96:99], v188, s[8:11], s24 offen
  buffer_load_dwordx4 v[100:103], v188, s[8:11], s23 offen offset:0
  buffer_load_dwordx4 v[104:107], v188, s[8:11], s23 offen offset:1024
  buffer_load_dwordx4 v[108:111], v188, s[8:11], s23 offen offset:2048
  buffer_load_dwordx4 v[112:115], v188, s[8:11], s23 offen offset:3072
  s_add_u32 s23, s23, 131072
  s_add_u32 s21, s21, 5120
  s_add_u32 s24, s21, 4096
  buffer_load_dwordx4 v[116:119], v188, s[8:11], s21 offen offset:0
  buffer_load_dwordx4 v[120:123], v188, s[8:11], s21 offen offset:1024
  buffer_load_dwordx4 v[124:127], v188, s[8:11], s21 offen offset:2048
  buffer_load_dwordx4 v[128:131], v188, s[8:11], s21 offen offset:3072
  buffer_load_dwordx4 v[132:135], v188, s[8:11], s24 offen
  buffer_load_dwordx4 v[136:139], v188, s[8:11], s23 offen offset:0
  buffer_load_dwordx4 v[140:143], v188, s[8:11], s23 offen offset:1024
  buffer_load_dwordx4 v[144:147], v188, s[8:11], s23 offen offset:2048
  buffer_load_dwordx4 v[148:151], v188, s[8:11], s23 offen offset:3072
  s_add_u32 s23, s23, 131072
  s_add_u32 s21, s21, 5120
  s_add_u32 s24, s21, 4096
  buffer_load_dwordx4 v[152:155], v188, s[8:11], s21 offen offset:0
  buffer_load_dwordx4 v[156:159], v188, s[8:11], s21 offen offset:1024
  buffer_load_dwordx4 v[160:163], v188, s[8:11], s21 offen offset:2048
  buffer_load_dwordx4 v[164:167], v188, s[8:11], s21 offen offset:3072
  buffer_load_dwordx4 v[168:171], v188, s[8:11], s24 offen
  buffer_load_dwordx4 v[172:175], v188, s[8:11], s23 offen offset:0
  buffer_load_dwordx4 v[176:179], v188, s[8:11], s23 offen offset:1024
  buffer_load_dwordx4 v[180:183], v188, s[8:11], s23 offen offset:2048
  buffer_load_dwordx4 v[184:187], v188, s[8:11], s23 offen offset:3072
  s_add_u32 s23, s23, 131072
  s_add_u32 s21, s21, 5120
  s_add_u32 s24, s21, 4096
  s_waitcnt vmcnt(21)
  v_mfma_f32_16x16x32_bf16 v[0:3], v[80:83], v[100:103], v[0:3]
  s_waitcnt vmcnt(20)
  v_mfma_f32_16x16x32_bf16 v[4:7], v[80:83], v[104:107], v[4:7]
  s_waitcnt vmcnt(19)
  v_mfma_f32_16x16x32_bf16 v[8:11], v[80:83], v[108:111], v[8:11]
  s_waitcnt vmcnt(18)
  v_mfma_f32_16x16x32_bf16 v[12:15], v[80:83], v[112:115], v[12:15]
  v_mfma_f32_16x16x32_bf16 v[16:19], v[84:87], v[100:103], v[16:19]
  v_mfma_f32_16x16x32_bf16 v[20:23], v[84:87], v[104:107], v[20:23]
  v_mfma_f32_16x16x32_bf16 v[24:27], v[84:87], v[108:111], v[24:27]
  v_mfma_f32_16x16x32_bf16 v[28:31], v[84:87], v[112:115], v[28:31]
  v_mfma_f32_16x16x32_bf16 v[32:35], v[88:91], v[100:103], v[32:35]
  v_mfma_f32_16x16x32_bf16 v[36:39], v[88:91], v[104:107], v[36:39]
  v_mfma_f32_16x16x32_bf16 v[40:43], v[88:91], v[108:111], v[40:43]
  v_mfma_f32_16x16x32_bf16 v[44:47], v[88:91], v[112:115], v[44:47]
  v_mfma_f32_16x16x32_bf16 v[48:51], v[92:95], v[100:103], v[48:51]
  v_mfma_f32_16x16x32_bf16 v[52:55], v[92:95], v[104:107], v[52:55]
  v_mfma_f32_16x16x32_bf16 v[56:59], v[92:95], v[108:111], v[56:59]
  v_mfma_f32_16x16x32_bf16 v[60:63], v[92:95], v[112:115], v[60:63]
  v_mfma_f32_16x16x32_bf16 v[64:67], v[96:99], v[100:103], v[64:67]
  v_mfma_f32_16x16x32_bf16 v[68:71], v[96:99], v[104:107], v[68:71]
  v_mfma_f32_16x16x32_bf16 v[72:75], v[96:99], v[108:111], v[72:75]
  v_mfma_f32_16x16x32_bf16 v[76:79], v[96:99], v[112:115], v[76:79]
  buffer_load_dwordx4 v[80:83], v188, s[8:11], s21 offen offset:0
  buffer_load_dwordx4 v[84:87], v188, s[8:11], s21 offen offset:1024
  buffer_load_dwordx4 v[88:91], v188, s[8:11], s21 offen offset:2048
  buffer_load_dwordx4 v[92:95], v188, s[8:11], s21 offen offset:3072
  buffer_load_dwordx4 v[96:99], v188, s[8:11], s24 offen
  buffer_load_dwordx4 v[100:103], v188, s[8:11], s23 offen offset:0
  buffer_load_dwordx4 v[104:107], v188, s[8:11], s23 offen offset:1024
  buffer_load_dwordx4 v[108:111], v188, s[8:11], s23 offen offset:2048
  buffer_load_dwordx4 v[112:115], v188, s[8:11], s23 offen offset:3072
  s_add_u32 s23, s23, 131072
  s_add_u32 s21, s21, 5120
  s_add_u32 s24, s21, 4096
  s_waitcnt vmcnt(21)
  v_mfma_f32_16x16x32_bf16 v[0:3], v[116:119], v[136:139], v[0:3]
  s_waitcnt vmcnt(20)
  v_mfma_f32_16x16x32_bf16 v[4:7], v[116:119], v[140:143], v[4:7]
  s_waitcnt vmcnt(19)
  v_mfma_f32_16x16x32_bf16 v[8:11], v[116:119], v[144:147], v[8:11]
  s_waitcnt vmcnt(18)
  v_mfma_f32_16x16x32_bf16 v[12:15], v[116:119], v[148:151], v[12:15]
  v_mfma_f32_16x16x32_bf16 v[16:19], v[120:123], v[136:139], v[16:19]
  v_mfma_f32_16x16x32_bf16 v[20:23], v[120:123], v[140:143], v[20:23]
  v_mfma_f32_16x16x32_bf16 v[24:27], v[120:123], v[144:147], v[24:27]
  v_mfma_f32_16x16x32_bf16 v[28:31], v[120:123], v[148:151], v[28:31]
  v_mfma_f32_16x16x32_bf16 v[32:35], v[124:127], v[136:139], v[32:35]
  v_mfma_f32_16x16x32_bf16 v[36:39], v[124:127], v[140:143], v[36:39]
  v_mfma_f32_16x16x32_bf16 v[40:43], v[124:127], v[144:147], v[40:43]
  v_mfma_f32_16x16x32_bf16 v[44:47], v[124:127], v[148:151], v[44:47]
  v_mfma_f32_16x16x32_bf16 v[48:51], v[128:131], v[136:139], v[48:51]
  v_mfma_f32_16x16x32_bf16 v[52:55], v[128:131], v[140:143], v[52:55]
  v_mfma_f32_16x16x32_bf16 v[56:59], v[128:131], v[144:147], v[56:59]
  v_mfma_f32_16x16x32_bf16 v[60:63], v[128:131], v[148:151], v[60:63]
  v_mfma_f32_16x16x32_bf16 v[64:67], v[132:135], v[136:139], v[64:67]
  v_mfma_f32_16x16x32_bf16 v[68:71], v[132:135], v[140:143], v[68:71]
  v_mfma_f32_16x16x32_bf16 v[72:75], v[132:135], v[144:147], v[72:75]
  v_mfma_f32_16x16x32_bf16 v[76:79], v[132:135], v[148:151], v[76:79]
  buffer_load_dwordx4 v[116:119], v188, s[8:11], s21 offen offset:0
  buffer_load_dwordx4 v[120:123], v188, s[8:11], s21 offen offset:1024
  buffer_load_dwordx4 v[124:127], v188, s[8:11], s21 offen offset:2048
  buffer_load_dwordx4 v[128:131], v188, s[8:11], s21 offen offset:3072
  buffer_load_dwordx4 v[132:135], v188, s[8:11], s24 offen
  buffer_load_dwordx4 v[136:139], v188, s[8:11], s23 offen offset:0
  buffer_load_dwordx4 v[140:143], v188, s[8:11], s23 offen offset:1024
  buffer_load_dwordx4 v[144:147], v188, s[8:11], s23 offen offset:2048
  buffer_load_dwordx4 v[148:151], v188, s[8:11], s23 offen offset:3072
  s_add_u32 s23, s23, 131072
  s_add_u32 s21, s21, 5120
  s_add_u32 s24, s21, 4096
  s_waitcnt vmcnt(21)
  v_mfma_f32_16x16x32_bf16 v[0:3], v[152:155], v[172:175], v[0:3]
  s_waitcnt vmcnt(20)
  v_mfma_f32_16x16x32_bf16 v[4:7], v[152:155], v[176:179], v[4:7]
  s_waitcnt vmcnt(19)
  v_mfma_f32_16x16x32_bf16 v[8:11], v[152:155], v[180:183], v[8:11]
  s_waitcnt vmcnt(18)
  v_mfma_f32_16x16x32_bf16 v[12:15], v[152:155], v[184:187], v[12:15]
  v_mfma_f32_16x16x32_bf16 v[16:19], v[156:159], v[172:175], v[16:19]
  v_mfma_f32_16x16x32_bf16 v[20:23], v[156:159], v[176:179], v[20:23]
  v_mfma_f32_16x16x32_bf16 v[24:27], v[156:159], v[180:183], v[24:27]
  v_mfma_f32_16x16x32_bf16 v[28:31], v[156:159], v[184:187], v[28:31]
  v_mfma_f32_16x16x32_bf16 v[32:35], v[160:163], v[172:175], v[32:35]
  v_mfma_f32_16x16x32_bf16 v[36:39], v[160:163], v[176:179], v[36:39]
  v_mfma_f32_16x16x32_bf16 v[40:43], v[160:163], v[180:183], v[40:43]
  v_mfma_f32_16x16x32_bf16 v[44:47], v[160:163], v[184:187], v[44:47]
  v_mfma_f32_16x16x32_bf16 v[48:51], v[164:167], v[172:175], v[48:51]
  v_mfma_f32_16x16x32_bf16 v[52:55], v[164:167], v[176:179], v[52:55]
  v_mfma_f32_16x16x32_bf16 v[56:59], v[164:167], v[180:183], v[56:59]
  v_mfma_f32_16x16x32_bf16 v[60:63], v[164:167], v[184:187], v[60:63]
  v_mfma_f32_16x16x32_bf16 v[64:67], v[168:171], v[172:175], v[64:67]
  v_mfma_f32_16x16x32_bf16 v[68:71], v[168:171], v[176:179], v[68:71]
  v_mfma_f32_16x16x32_bf16 v[72:75], v[168:171], v[180:183], v[72:75]
  v_mfma_f32_16x16x32_bf16 v[76:79], v[168:171], v[184:187], v[76:79]
  buffer_load_dwordx4 v[152:155], v188, s[8:11], s21 offen offset:0
  buffer_load_dwordx4 v[156:159], v188, s[8:11], s21 offen offset:1024
  buffer_load_dwordx4 v[160:163], v188, s[8:11], s21 offen offset:2048
  buffer_load_dwordx4 v[164:167], v188, s[8:11], s21 offen offset:3072
  buffer_load_dwordx4 v[168:171], v188, s[8:11], s24 offen
  buffer_load_dwordx4 v[172:175], v188, s[8:11], s23 offen offset:0
  buffer_load_dwordx4 v[176:179], v188, s[8:11], s23 offen offset:1024
  buffer_load_dwordx4 v[180:183], v188, s[8:11], s23 offen offset:2048
  buffer_load_dwordx4 v[184:187], v188, s[8:11], s23 offen offset:3072
  s_add_u32 s23, s23, 131072
  s_add_u32 s21, s21, 5120
  s_add_u32 s24, s21, 4096
  s_waitcnt vmcnt(21)
  v_mfma_f32_16x16x32_bf16 v[0:3], v[80:83], v[100:103], v[0:3]
  s_waitcnt vmcnt(20)
  v_mfma_f32_16x16x32_bf16 v[4:7], v[80:83], v[104:107], v[4:7]
  s_waitcnt vmcnt(19)
  v_mfma_f32_16x16x32_bf16 v[8:11], v[80:83], v[108:111], v[8:11]
  s_waitcnt vmcnt(18)
  v_mfma_f32_16x16x32_bf16 v[12:15], v[80:83], v[112:115], v[12:15]
  v_mfma_f32_16x16x32_bf16 v[16:19], v[84:87], v[100:103], v[16:19]
  v_mfma_f32_16x16x32_bf16 v[20:23], v[84:87], v[104:107], v[20:23]
  v_mfma_f32_16x16x32_bf16 v[24:27], v[84:87], v[108:111], v[24:27]
  v_mfma_f32_16x16x32_bf16 v[28:31], v[84:87], v[112:115], v[28:31]
  v_mfma_f32_16x16x32_bf16 v[32:35], v[88:91], v[100:103], v[32:35]
  v_mfma_f32_16x16x32_bf16 v[36:39], v[88:91], v[104:107], v[36:39]
  v_mfma_f32_16x16x32_bf16 v[40:43], v[88:91], v[108:111], v[40:43]
  v_mfma_f32_16x16x32_bf16 v[44:47], v[88:91], v[112:115], v[44:47]
  v_mfma_f32_16x16x32_bf16 v[48:51], v[92:95], v[100:103], v[48:51]
  v_mfma_f32_16x16x32_bf16 v[52:55], v[92:95], v[104:107], v[52:55]
  v_mfma_f32_16x16x32_bf16 v[56:59], v[92:95], v[108:111], v[56:59]
  v_mfma_f32_16x16x32_bf16 v[60:63], v[92:95], v[112:115], v[60:63]
  v_mfma_f32_16x16x32_bf16 v[64:67], v[96:99], v[100:103], v[64:67]
  v_mfma_f32_16x16x32_bf16 v[68:71], v[96:99], v[104:107], v[68:71]
  v_mfma_f32_16x16x32_bf16 v[72:75], v[96:99], v[108:111], v[72:75]
  v_mfma_f32_16x16x32_bf16 v[76:79], v[96:99], v[112:115], v[76:79]
  buffer_load_dwordx4 v[80:83], v188, s[8:11], s21 offen offset:0
  buffer_load_dwordx4 v[84:87], v188, s[8:11], s21 offen offset:1024
  buffer_load_dwordx4 v[88:91], v188, s[8:11], s21 offen offset:2048
  buffer_load_dwordx4 v[92:95], v188, s[8:11], s21 offen offset:3072
  buffer_load_dwordx4 v[96:99], v188, s[8:11], s24 offen
  buffer_load_dwordx4 v[100:103], v188, s[8:11], s23 offen offset:0
  buffer_load_dwordx4 v[104:107], v188, s[8:11], s23 offen offset:1024
  buffer_load_dwordx4 v[108:111], v188, s[8:11], s23 offen offset:2048
  buffer_load_dwordx4 v[112:115], v188, s[8:11], s23 offen offset:3072
  s_add_u32 s23, s23, 131072
  s_add_u32 s21, s21, 5120
  s_add_u32 s24, s21, 4096
  s_waitcnt vmcnt(21)
  v_mfma_f32_16x16x32_bf16 v[0:3], v[116:119], v[136:139], v[0:3]
  s_waitcnt vmcnt(20)
  v_mfma_f32_16x16x32_bf16 v[4:7], v[116:119], v[140:143], v[4:7]
  s_waitcnt vmcnt(19)
  v_mfma_f32_16x16x32_bf16 v[8:11], v[116:119], v[144:147], v[8:11]
  s_waitcnt vmcnt(18)
  v_mfma_f32_16x16x32_bf16 v[12:15], v[116:119], v[148:151], v[12:15]
  v_mfma_f32_16x16x32_bf16 v[16:19], v[120:123], v[136:139], v[16:19]
  v_mfma_f32_16x16x32_bf16 v[20:23], v[120:123], v[140:143], v[20:23]
  v_mfma_f32_16x16x32_bf16 v[24:27], v[120:123], v[144:147], v[24:27]
  v_mfma_f32_16x16x32_bf16 v[28:31], v[120:123], v[148:151], v[28:31]
  v_mfma_f32_16x16x32_bf16 v[32:35], v[124:127], v[136:139], v[32:35]
  v_mfma_f32_16x16x32_bf16 v[36:39], v[124:127], v[140:143], v[36:39]
  v_mfma_f32_16x16x32_bf16 v[40:43], v[124:127], v[144:147], v[40:43]
  v_mfma_f32_16x16x32_bf16 v[44:47], v[124:127], v[148:151], v[44:47]
  v_mfma_f32_16x16x32_bf16 v[48:51], v[128:131], v[136:139], v[48:51]
  v_mfma_f32_16x16x32_bf16 v[52:55], v[128:131], v[140:143], v[52:55]
  v_mfma_f32_16x16x32_bf16 v[56:59], v[128:131], v[144:147], v[56:59]
  v_mfma_f32_16x16x32_bf16 v[60:63], v[128:131], v[148:151], v[60:63]
  v_mfma_f32_16x16x32_bf16 v[64:67], v[132:135], v[136:139], v[64:67]
  v_mfma_f32_16x16x32_bf16 v[68:71], v[132:135], v[140:143], v[68:71]
  v_mfma_f32_16x16x32_bf16 v[72:75], v[132:135], v[144:147], v[72:75]
  v_mfma_f32_16x16x32_bf16 v[76:79], v[132:135], v[148:151], v[76:79]
  buffer_load_dwordx4 v[116:119], v188, s[8:11], s21 offen offset:0
  buffer_load_dwordx4 v[120:123], v188, s[8:11], s21 offen offset:1024
  buffer_load_dwordx4 v[124:127], v188, s[8:11], s21 offen offset:2048
  buffer_load_dwordx4 v[128:131], v188, s[8:11], s21 offen offset:3072
  buffer_load_dwordx4 v[132:135], v188, s[8:11], s24 offen
  buffer_load_dwordx4 v[136:139], v188, s[8:11], s23 offen offset:0
  buffer_load_dwordx4 v[140:143], v188, s[8:11], s23 offen offset:1024
  buffer_load_dwordx4 v[144:147], v188, s[8:11], s23 offen offset:2048
  buffer_load_dwordx4 v[148:151], v188, s[8:11], s23 offen offset:3072
  s_add_u32 s23, s23, 131072
  s_add_u32 s21, s21, 5120
  s_add_u32 s24, s21, 4096
  s_waitcnt vmcnt(21)
  v_mfma_f32_16x16x32_bf16 v[0:3], v[152:155], v[172:175], v[0:3]
  s_waitcnt vmcnt(20)
  v_mfma_f32_16x16x32_bf16 v[4:7], v[152:155], v[176:179], v[4:7]
  s_waitcnt vmcnt(19)
  v_mfma_f32_16x16x32_bf16 v[8:11], v[152:155], v[180:183], v[8:11]
  s_waitcnt vmcnt(18)
  v_mfma_f32_16x16x32_bf16 v[12:15], v[152:155], v[184:187], v[12:15]
  v_mfma_f32_16x16x32_bf16 v[16:19], v[156:159], v[172:175], v[16:19]
  v_mfma_f32_16x16x32_bf16 v[20:23], v[156:159], v[176:179], v[20:23]
  v_mfma_f32_16x16x32_bf16 v[24:27], v[156:159], v[180:183], v[24:27]
  v_mfma_f32_16x16x32_bf16 v[28:31], v[156:159], v[184:187], v[28:31]
  v_mfma_f32_16x16x32_bf16 v[32:35], v[160:163], v[172:175], v[32:35]
  v_mfma_f32_16x16x32_bf16 v[36:39], v[160:163], v[176:179], v[36:39]
  v_mfma_f32_16x16x32_bf16 v[40:43], v[160:163], v[180:183], v[40:43]
  v_mfma_f32_16x16x32_bf16 v[44:47], v[160:163], v[184:187], v[44:47]
  v_mfma_f32_16x16x32_bf16 v[48:51], v[164:167], v[172:175], v[48:51]
  v_mfma_f32_16x16x32_bf16 v[52:55], v[164:167], v[176:179], v[52:55]
  v_mfma_f32_16x16x32_bf16 v[56:59], v[164:167], v[180:183], v[56:59]
  v_mfma_f32_16x16x32_bf16 v[60:63], v[164:167], v[184:187], v[60:63]
  v_mfma_f32_16x16x32_bf16 v[64:67], v[168:171], v[172:175], v[64:67]
  v_mfma_f32_16x16x32_bf16 v[68:71], v[168:171], v[176:179], v[68:71]
  v_mfma_f32_16x16x32_bf16 v[72:75], v[168:171], v[180:183], v[72:75]
  v_mfma_f32_16x16x32_bf16 v[76:79], v[168:171], v[184:187], v[76:79]
  buffer_load_dwordx4 v[152:155], v188, s[8:11], s21 offen offset:0
  buffer_load_dwordx4 v[156:159], v188, s[8:11], s21 offen offset:1024
  buffer_load_dwordx4 v[160:163], v188, s[8:11], s21 offen offset:2048
  buffer_load_dwordx4 v[164:167], v188, s[8:11], s21 offen offset:3072
  buffer_load_dwordx4 v[168:171], v188, s[8:11], s24 offen
  buffer_load_dwordx4 v[172:175], v188, s[8:11], s23 offen offset:0
  buffer_load_dwordx4 v[176:179], v188, s[8:11], s23 offen offset:1024
  buffer_load_dwordx4 v[180:183], v188, s[8:11], s23 offen offset:2048
  buffer_load_dwordx4 v[184:187], v188, s[8:11], s23 offen offset:3072
  s_add_u32 s23, s23, 131072
  s_add_u32 s21, s21, 5120
  s_add_u32 s24, s21, 4096
  s_waitcnt vmcnt(21)
  v_mfma_f32_16x16x32_bf16 v[0:3], v[80:83], v[100:103], v[0:3]
  s_waitcnt vmcnt(20)
  v_mfma_f32_16x16x32_bf16 v[4:7], v[80:83], v[104:107], v[4:7]
  s_waitcnt vmcnt(19)
  v_mfma_f32_16x16x32_bf16 v[8:11], v[80:83], v[108:111], v[8:11]
  s_waitcnt vmcnt(18)
  v_mfma_f32_16x16x32_bf16 v[12:15], v[80:83], v[112:115], v[12:15]
  v_mfma_f32_16x16x32_bf16 v[16:19], v[84:87], v[100:103], v[16:19]
  v_mfma_f32_16x16x32_bf16 v[20:23], v[84:87], v[104:107], v[20:23]
  v_mfma_f32_16x16x32_bf16 v[24:27], v[84:87], v[108:111], v[24:27]
  v_mfma_f32_16x16x32_bf16 v[28:31], v[84:87], v[112:115], v[28:31]
  v_mfma_f32_16x16x32_bf16 v[32:35], v[88:91], v[100:103], v[32:35]
  v_mfma_f32_16x16x32_bf16 v[36:39], v[88:91], v[104:107], v[36:39]
  v_mfma_f32_16x16x32_bf16 v[40:43], v[88:91], v[108:111], v[40:43]
  v_mfma_f32_16x16x32_bf16 v[44:47], v[88:91], v[112:115], v[44:47]
  v_mfma_f32_16x16x32_bf16 v[48:51], v[92:95], v[100:103], v[48:51]
  v_mfma_f32_16x16x32_bf16 v[52:55], v[92:95], v[104:107], v[52:55]
  v_mfma_f32_16x16x32_bf16 v[56:59], v[92:95], v[108:111], v[56:59]
  v_mfma_f32_16x16x32_bf16 v[60:63], v[92:95], v[112:115], v[60:63]
  v_mfma_f32_16x16x32_bf16 v[64:67], v[96:99], v[100:103], v[64:67]
  v_mfma_f32_16x16x32_bf16 v[68:71], v[96:99], v[104:107], v[68:71]
  v_mfma_f32_16x16x32_bf16 v[72:75], v[96:99], v[108:111], v[72:75]
  v_mfma_f32_16x16x32_bf16 v[76:79], v[96:99], v[112:115], v[76:79]
  s_waitcnt vmcnt(12)
  v_mfma_f32_16x16x32_bf16 v[0:3], v[116:119], v[136:139], v[0:3]
  s_waitcnt vmcnt(11)
  v_mfma_f32_16x16x32_bf16 v[4:7], v[116:119], v[140:143], v[4:7]
  s_waitcnt vmcnt(10)
  v_mfma_f32_16x16x32_bf16 v[8:11], v[116:119], v[144:147], v[8:11]
  s_waitcnt vmcnt(9)
  v_mfma_f32_16x16x32_bf16 v[12:15], v[116:119], v[148:151], v[12:15]
  v_mfma_f32_16x16x32_bf16 v[16:19], v[120:123], v[136:139], v[16:19]
  v_mfma_f32_16x16x32_bf16 v[20:23], v[120:123], v[140:143], v[20:23]
  v_mfma_f32_16x16x32_bf16 v[24:27], v[120:123], v[144:147], v[24:27]
  v_mfma_f32_16x16x32_bf16 v[28:31], v[120:123], v[148:151], v[28:31]
  v_mfma_f32_16x16x32_bf16 v[32:35], v[124:127], v[136:139], v[32:35]
  v_mfma_f32_16x16x32_bf16 v[36:39], v[124:127], v[140:143], v[36:39]
  v_mfma_f32_16x16x32_bf16 v[40:43], v[124:127], v[144:147], v[40:43]
  v_mfma_f32_16x16x32_bf16 v[44:47], v[124:127], v[148:151], v[44:47]
  v_mfma_f32_16x16x32_bf16 v[48:51], v[128:131], v[136:139], v[48:51]
  v_mfma_f32_16x16x32_bf16 v[52:55], v[128:131], v[140:143], v[52:55]
  v_mfma_f32_16x16x32_bf16 v[56:59], v[128:131], v[144:147], v[56:59]
  v_mfma_f32_16x16x32_bf16 v[60:63], v[128:131], v[148:151], v[60:63]
  v_mfma_f32_16x16x32_bf16 v[64:67], v[132:135], v[136:139], v[64:67]
  v_mfma_f32_16x16x32_bf16 v[68:71], v[132:135], v[140:143], v[68:71]
  v_mfma_f32_16x16x32_bf16 v[72:75], v[132:135], v[144:147], v[72:75]
  v_mfma_f32_16x16x32_bf16 v[76:79], v[132:135], v[148:151], v[76:79]
  s_waitcnt vmcnt(3)
  v_mfma_f32_16x16x32_bf16 v[0:3], v[152:155], v[172:175], v[0:3]
  s_waitcnt vmcnt(2)
  v_mfma_f32_16x16x32_bf16 v[4:7], v[152:155], v[176:179], v[4:7]
  s_waitcnt vmcnt(1)
  v_mfma_f32_16x16x32_bf16 v[8:11], v[152:155], v[180:183], v[8:11]
  s_waitcnt vmcnt(0)
  v_mfma_f32_16x16x32_bf16 v[12:15], v[152:155], v[184:187], v[12:15]
  v_mfma_f32_16x16x32_bf16 v[16:19], v[156:159], v[172:175], v[16:19]
  v_mfma_f32_16x16x32_bf16 v[20:23], v[156:159], v[176:179], v[20:23]
  v_mfma_f32_16x16x32_bf16 v[24:27], v[156:159], v[180:183], v[24:27]
  v_mfma_f32_16x16x32_bf16 v[28:31], v[156:159], v[184:187], v[28:31]
  v_mfma_f32_16x16x32_bf16 v[32:35], v[160:163], v[172:175], v[32:35]
  v_mfma_f32_16x16x32_bf16 v[36:39], v[160:163], v[176:179], v[36:39]
  v_mfma_f32_16x16x32_bf16 v[40:43], v[160:163], v[180:183], v[40:43]
  v_mfma_f32_16x16x32_bf16 v[44:47], v[160:163], v[184:187], v[44:47]
  v_mfma_f32_16x16x32_bf16 v[48:51], v[164:167], v[172:175], v[48:51]
  v_mfma_f32_16x16x32_bf16 v[52:55], v[164:167], v[176:179], v[52:55]
  v_mfma_f32_16x16x32_bf16 v[56:59], v[164:167], v[180:183], v[56:59]
  v_mfma_f32_16x16x32_bf16 v[60:63], v[164:167], v[184:187], v[60:63]
  v_mfma_f32_16x16x32_bf16 v[64:67], v[168:171], v[172:175], v[64:67]
  v_mfma_f32_16x16x32_bf16 v[68:71], v[168:171], v[176:179], v[68:71]
  v_mfma_f32_16x16x32_bf16 v[72:75], v[168:171], v[180:183], v[72:75]
  v_mfma_f32_16x16x32_bf16 v[76:79], v[168:171], v[184:187], v[76:79]
  s_lshl_b32 s25, s17, 6
  s_lshl_b32 s26, s16, 4
  s_add_u32 s25, s25, s26
  v_add_u32 v198, s25, v196
  v_lshlrev_b32 v199, 2, v198
  s_mov_b32 s27, 18251776
  buffer_load_dword v200, v199, s[8:11], s27 offen
  s_mul_i32 s28, s16, 20480
  v_lshlrev_b32 v201, 4, v195
  v_add_u32 v201, s28, v201
  ds_write_b128 v201, v[0:3] offset:0
  ds_write_b128 v201, v[16:19] offset:1024
  ds_write_b128 v201, v[32:35] offset:2048
  ds_write_b128 v201, v[48:51] offset:3072
  ds_write_b128 v201, v[64:67] offset:4096
  ds_write_b128 v201, v[4:7] offset:5120
  ds_write_b128 v201, v[20:23] offset:6144
  ds_write_b128 v201, v[36:39] offset:7168
  ds_write_b128 v201, v[52:55] offset:8192
  ds_write_b128 v201, v[68:71] offset:9216
  ds_write_b128 v201, v[8:11] offset:10240
  ds_write_b128 v201, v[24:27] offset:11264
  ds_write_b128 v201, v[40:43] offset:12288
  ds_write_b128 v201, v[56:59] offset:13312
  ds_write_b128 v201, v[72:75] offset:14336
  s_waitcnt lgkmcnt(13)
  ds_write_b128 v201, v[12:15] offset:15360
  ds_write_b128 v201, v[28:31] offset:16384
  s_waitcnt lgkmcnt(13)
  ds_write_b128 v201, v[44:47] offset:17408
  ds_write_b128 v201, v[60:63] offset:18432
  s_waitcnt lgkmcnt(13)
  ds_write_b128 v201, v[76:79] offset:19456
  s_waitcnt lgkmcnt(0)
  s_barrier
  s_mul_i32 s28, s16, 5120
  v_lshlrev_b32 v201, 4, v195
  v_add_u32 v201, s28, v201
  v_add_u32 v206, 40960, v201
  ds_read_b128 v[80:83], v201 offset:0
  ds_read_b128 v[84:87], v201 offset:1024
  ds_read_b128 v[88:91], v201 offset:2048
  ds_read_b128 v[92:95], v201 offset:3072
  ds_read_b128 v[96:99], v201 offset:4096
  ds_read_b128 v[100:103], v201 offset:20480
  ds_read_b128 v[104:107], v201 offset:21504
  ds_read_b128 v[108:111], v201 offset:22528
  ds_read_b128 v[112:115], v201 offset:23552
  ds_read_b128 v[116:119], v201 offset:24576
  ds_read_b128 v[120:123], v206 offset:0
  ds_read_b128 v[124:127], v206 offset:1024
  ds_read_b128 v[128:131], v206 offset:2048
  ds_read_b128 v[132:135], v206 offset:3072
  ds_read_b128 v[136:139], v206 offset:4096
  s_waitcnt lgkmcnt(13)
  ds_read_b128 v[140:143], v206 offset:20480
  ds_read_b128 v[144:147], v206 offset:21504
  s_waitcnt lgkmcnt(13)
  ds_read_b128 v[148:151], v206 offset:22528
  ds_read_b128 v[152:155], v206 offset:23552
  s_waitcnt lgkmcnt(13)
  ds_read_b128 v[156:159], v206 offset:24576
  s_waitcnt vmcnt(0)
  v_sub_f32 v202, 1.0, v200
  v_cvt_pk_bf16_f32 v202, v202, v202
  v_lshlrev_b32 v202, 16, v202
  v_mul_u32_u24 v203, 1152, v198
  s_mul_i32 s29, s18, 144
  v_lshl_add_u32 v203, v197, 3, v203
  v_add_u32 v203, s29, v203
  v_cmp_gt_u32 vcc, 2, v197
  v_mov_b32 v205, 0x7ffffff0
  s_nop 0
  v_cndmask_b32 v204, v205, v203, vcc
  v_add_f32 v80, v80, v100
  s_waitcnt lgkmcnt(4)
  v_add_f32 v120, v120, v140
  v_add_f32 v81, v81, v101
  v_add_f32 v121, v121, v141
  v_add_f32 v82, v82, v102
  v_add_f32 v122, v122, v142
  v_add_f32 v83, v83, v103
  v_add_f32 v123, v123, v143
  v_cvt_pk_bf16_f32 v0, v80, v81
  v_cvt_pk_bf16_f32 v1, v82, v83
  v_cvt_pk_bf16_f32 v4, v120, v121
  v_cvt_pk_bf16_f32 v5, v122, v123
  v_lshlrev_b32 v80, 16, v0
  v_and_b32 v81, 0xffff0000, v0
  v_lshlrev_b32 v82, 16, v1
  v_and_b32 v83, 0xffff0000, v1
  v_mul_f32 v80, v200, v80
  v_mul_f32 v81, v200, v81
  v_mul_f32 v82, v200, v82
  v_mul_f32 v83, v200, v83
  v_lshlrev_b32 v120, 16, v4
  v_and_b32 v121, 0xffff0000, v4
  v_lshlrev_b32 v122, 16, v5
  v_and_b32 v123, 0xffff0000, v5
  v_mul_f32 v120, v202, v120
  v_mul_f32 v121, v202, v121
  v_mul_f32 v122, v202, v122
  v_mul_f32 v123, v202, v123
  v_cvt_pk_bf16_f32 v0, v80, v81
  v_cvt_pk_bf16_f32 v1, v82, v83
  v_cvt_pk_bf16_f32 v4, v120, v121
  v_cvt_pk_bf16_f32 v5, v122, v123
  v_lshlrev_b32 v80, 16, v0
  v_and_b32 v81, 0xffff0000, v0
  v_lshlrev_b32 v82, 16, v1
  v_and_b32 v83, 0xffff0000, v1
  v_lshlrev_b32 v120, 16, v4
  v_and_b32 v121, 0xffff0000, v4
  v_lshlrev_b32 v122, 16, v5
  v_and_b32 v123, 0xffff0000, v5
  v_add_f32 v80, v80, v120
  v_add_f32 v81, v81, v121
  v_add_f32 v82, v82, v122
  v_add_f32 v83, v83, v123
  v_cvt_pk_bf16_f32 v8, v80, v81
  v_cvt_pk_bf16_f32 v9, v82, v83
  buffer_store_dwordx2 v[8:9], v203, s[12:15], 0 offen offset:0
  v_add_f32 v84, v84, v104
  s_waitcnt lgkmcnt(3)
  v_add_f32 v124, v124, v144
  v_add_f32 v85, v85, v105
  v_add_f32 v125, v125, v145
  v_add_f32 v86, v86, v106
  v_add_f32 v126, v126, v146
  v_add_f32 v87, v87, v107
  v_add_f32 v127, v127, v147
  v_cvt_pk_bf16_f32 v16, v84, v85
  v_cvt_pk_bf16_f32 v17, v86, v87
  v_cvt_pk_bf16_f32 v20, v124, v125
  v_cvt_pk_bf16_f32 v21, v126, v127
  v_lshlrev_b32 v84, 16, v16
  v_and_b32 v85, 0xffff0000, v16
  v_lshlrev_b32 v86, 16, v17
  v_and_b32 v87, 0xffff0000, v17
  v_mul_f32 v84, v200, v84
  v_mul_f32 v85, v200, v85
  v_mul_f32 v86, v200, v86
  v_mul_f32 v87, v200, v87
  v_lshlrev_b32 v124, 16, v20
  v_and_b32 v125, 0xffff0000, v20
  v_lshlrev_b32 v126, 16, v21
  v_and_b32 v127, 0xffff0000, v21
  v_mul_f32 v124, v202, v124
  v_mul_f32 v125, v202, v125
  v_mul_f32 v126, v202, v126
  v_mul_f32 v127, v202, v127
  v_cvt_pk_bf16_f32 v16, v84, v85
  v_cvt_pk_bf16_f32 v17, v86, v87
  v_cvt_pk_bf16_f32 v20, v124, v125
  v_cvt_pk_bf16_f32 v21, v126, v127
  v_lshlrev_b32 v84, 16, v16
  v_and_b32 v85, 0xffff0000, v16
  v_lshlrev_b32 v86, 16, v17
  v_and_b32 v87, 0xffff0000, v17
  v_lshlrev_b32 v124, 16, v20
  v_and_b32 v125, 0xffff0000, v20
  v_lshlrev_b32 v126, 16, v21
  v_and_b32 v127, 0xffff0000, v21
  v_add_f32 v84, v84, v124
  v_add_f32 v85, v85, v125
  v_add_f32 v86, v86, v126
  v_add_f32 v87, v87, v127
  v_cvt_pk_bf16_f32 v24, v84, v85
  v_cvt_pk_bf16_f32 v25, v86, v87
  buffer_store_dwordx2 v[24:25], v203, s[12:15], 0 offen offset:32
  v_add_f32 v88, v88, v108
  s_waitcnt lgkmcnt(2)
  v_add_f32 v128, v128, v148
  v_add_f32 v89, v89, v109
  v_add_f32 v129, v129, v149
  v_add_f32 v90, v90, v110
  v_add_f32 v130, v130, v150
  v_add_f32 v91, v91, v111
  v_add_f32 v131, v131, v151
  v_cvt_pk_bf16_f32 v32, v88, v89
  v_cvt_pk_bf16_f32 v33, v90, v91
  v_cvt_pk_bf16_f32 v36, v128, v129
  v_cvt_pk_bf16_f32 v37, v130, v131
  v_lshlrev_b32 v88, 16, v32
  v_and_b32 v89, 0xffff0000, v32
  v_lshlrev_b32 v90, 16, v33
  v_and_b32 v91, 0xffff0000, v33
  v_mul_f32 v88, v200, v88
  v_mul_f32 v89, v200, v89
  v_mul_f32 v90, v200, v90
  v_mul_f32 v91, v200, v91
  v_lshlrev_b32 v128, 16, v36
  v_and_b32 v129, 0xffff0000, v36
  v_lshlrev_b32 v130, 16, v37
  v_and_b32 v131, 0xffff0000, v37
  v_mul_f32 v128, v202, v128
  v_mul_f32 v129, v202, v129
  v_mul_f32 v130, v202, v130
  v_mul_f32 v131, v202, v131
  v_cvt_pk_bf16_f32 v32, v88, v89
  v_cvt_pk_bf16_f32 v33, v90, v91
  v_cvt_pk_bf16_f32 v36, v128, v129
  v_cvt_pk_bf16_f32 v37, v130, v131
  v_lshlrev_b32 v88, 16, v32
  v_and_b32 v89, 0xffff0000, v32
  v_lshlrev_b32 v90, 16, v33
  v_and_b32 v91, 0xffff0000, v33
  v_lshlrev_b32 v128, 16, v36
  v_and_b32 v129, 0xffff0000, v36
  v_lshlrev_b32 v130, 16, v37
  v_and_b32 v131, 0xffff0000, v37
  v_add_f32 v88, v88, v128
  v_add_f32 v89, v89, v129
  v_add_f32 v90, v90, v130
  v_add_f32 v91, v91, v131
  v_cvt_pk_bf16_f32 v40, v88, v89
  v_cvt_pk_bf16_f32 v41, v90, v91
  buffer_store_dwordx2 v[40:41], v203, s[12:15], 0 offen offset:64
  v_add_f32 v92, v92, v112
  s_waitcnt lgkmcnt(1)
  v_add_f32 v132, v132, v152
  v_add_f32 v93, v93, v113
  v_add_f32 v133, v133, v153
  v_add_f32 v94, v94, v114
  v_add_f32 v134, v134, v154
  v_add_f32 v95, v95, v115
  v_add_f32 v135, v135, v155
  v_cvt_pk_bf16_f32 v48, v92, v93
  v_cvt_pk_bf16_f32 v49, v94, v95
  v_cvt_pk_bf16_f32 v52, v132, v133
  v_cvt_pk_bf16_f32 v53, v134, v135
  v_lshlrev_b32 v92, 16, v48
  v_and_b32 v93, 0xffff0000, v48
  v_lshlrev_b32 v94, 16, v49
  v_and_b32 v95, 0xffff0000, v49
  v_mul_f32 v92, v200, v92
  v_mul_f32 v93, v200, v93
  v_mul_f32 v94, v200, v94
  v_mul_f32 v95, v200, v95
  v_lshlrev_b32 v132, 16, v52
  v_and_b32 v133, 0xffff0000, v52
  v_lshlrev_b32 v134, 16, v53
  v_and_b32 v135, 0xffff0000, v53
  v_mul_f32 v132, v202, v132
  v_mul_f32 v133, v202, v133
  v_mul_f32 v134, v202, v134
  v_mul_f32 v135, v202, v135
  v_cvt_pk_bf16_f32 v48, v92, v93
  v_cvt_pk_bf16_f32 v49, v94, v95
  v_cvt_pk_bf16_f32 v52, v132, v133
  v_cvt_pk_bf16_f32 v53, v134, v135
  v_lshlrev_b32 v92, 16, v48
  v_and_b32 v93, 0xffff0000, v48
  v_lshlrev_b32 v94, 16, v49
  v_and_b32 v95, 0xffff0000, v49
  v_lshlrev_b32 v132, 16, v52
  v_and_b32 v133, 0xffff0000, v52
  v_lshlrev_b32 v134, 16, v53
  v_and_b32 v135, 0xffff0000, v53
  v_add_f32 v92, v92, v132
  v_add_f32 v93, v93, v133
  v_add_f32 v94, v94, v134
  v_add_f32 v95, v95, v135
  v_cvt_pk_bf16_f32 v56, v92, v93
  v_cvt_pk_bf16_f32 v57, v94, v95
  buffer_store_dwordx2 v[56:57], v203, s[12:15], 0 offen offset:96
  v_add_f32 v96, v96, v116
  s_waitcnt lgkmcnt(0)
  v_add_f32 v136, v136, v156
  v_add_f32 v97, v97, v117
  v_add_f32 v137, v137, v157
  v_add_f32 v98, v98, v118
  v_add_f32 v138, v138, v158
  v_add_f32 v99, v99, v119
  v_add_f32 v139, v139, v159
  v_cvt_pk_bf16_f32 v64, v96, v97
  v_cvt_pk_bf16_f32 v65, v98, v99
  v_cvt_pk_bf16_f32 v68, v136, v137
  v_cvt_pk_bf16_f32 v69, v138, v139
  v_lshlrev_b32 v96, 16, v64
  v_and_b32 v97, 0xffff0000, v64
  v_lshlrev_b32 v98, 16, v65
  v_and_b32 v99, 0xffff0000, v65
  v_mul_f32 v96, v200, v96
  v_mul_f32 v97, v200, v97
  v_mul_f32 v98, v200, v98
  v_mul_f32 v99, v200, v99
  v_lshlrev_b32 v136, 16, v68
  v_and_b32 v137, 0xffff0000, v68
  v_lshlrev_b32 v138, 16, v69
  v_and_b32 v139, 0xffff0000, v69
  v_mul_f32 v136, v202, v136
  v_mul_f32 v137, v202, v137
  v_mul_f32 v138, v202, v138
  v_mul_f32 v139, v202, v139
  v_cvt_pk_bf16_f32 v64, v96, v97
  v_cvt_pk_bf16_f32 v65, v98, v99
  v_cvt_pk_bf16_f32 v68, v136, v137
  v_cvt_pk_bf16_f32 v69, v138, v139
  v_lshlrev_b32 v96, 16, v64
  v_and_b32 v97, 0xffff0000, v64
  v_lshlrev_b32 v98, 16, v65
  v_and_b32 v99, 0xffff0000, v65
  v_lshlrev_b32 v136, 16, v68
  v_and_b32 v137, 0xffff0000, v68
  v_lshlrev_b32 v138, 16, v69
  v_and_b32 v139, 0xffff0000, v69
  v_add_f32 v96, v96, v136
  v_add_f32 v97, v97, v137
  v_add_f32 v98, v98, v138
  v_add_f32 v99, v99, v139
  v_cvt_pk_bf16_f32 v72, v96, v97
  v_cvt_pk_bf16_f32 v73, v98, v99
  buffer_store_dwordx2 v[72:73], v204, s[12:15], 0 offen offset:128
k2b_end:
  s_waitcnt vmcnt(0)
  s_nop 15
  s_nop 7
  s_endpgm
.section .rodata,"a"
.p2align 6
.amdhsa_kernel k1_kernel
  .amdhsa_next_free_vgpr 256
  .amdhsa_next_free_sgpr 56
  .amdhsa_accum_offset 256
  .amdhsa_group_segment_fixed_size 0
  .amdhsa_kernarg_size 88
  .amdhsa_user_sgpr_count 2
  .amdhsa_user_sgpr_kernarg_segment_ptr 1
  .amdhsa_system_sgpr_workgroup_id_x 1
.end_amdhsa_kernel
.section .rodata,"a"
.p2align 6
.amdhsa_kernel k2a_kernel
  .amdhsa_next_free_vgpr 240
  .amdhsa_next_free_sgpr 60
  .amdhsa_accum_offset 240
  .amdhsa_group_segment_fixed_size 0
  .amdhsa_kernarg_size 88
  .amdhsa_user_sgpr_count 2
  .amdhsa_user_sgpr_kernarg_segment_ptr 1
  .amdhsa_system_sgpr_workgroup_id_x 1
.end_amdhsa_kernel
.section .rodata,"a"
.p2align 6
.amdhsa_kernel k2b_kernel
  .amdhsa_next_free_vgpr 208
  .amdhsa_next_free_sgpr 40
  .amdhsa_accum_offset 208
  .amdhsa_group_segment_fixed_size 0
  .amdhsa_kernarg_size 88
  .amdhsa_user_sgpr_count 2
  .amdhsa_user_sgpr_kernarg_segment_ptr 1
  .amdhsa_system_sgpr_workgroup_id_x 1
.end_amdhsa_kernel
```
